```python
import torch

def _softmax(x, axis=-1):
    return torch.softmax(x, dim=axis)
def _gelu(x):
    return torch.nn.functional.gelu(x, approximate="tanh")
def _silu(x):
    return torch.nn.functional.silu(x)
def _sigmoid(x):
    return torch.sigmoid(x)
def _layernorm(x, axis=-1, eps=1e-5):
    m = x.mean(dim=axis, keepdim=True)
    v = x.var(dim=axis, keepdim=True, unbiased=False)
    return (x - m) / torch.sqrt(v + eps)
def _scatter_add(tgt, idx, src, axis=0):
    return tgt.clone().index_add_(axis, idx, src)
def _segment_sum(src, seg, n):
    out = torch.zeros((n,) + src.shape[1:], dtype=src.dtype)
    return out.index_add_(0, seg, src)
def _pad(x, pw):
    flat = tuple(v for pair in reversed(pw) for v in pair)
    return torch.nn.functional.pad(x, flat)

kernel_name = 'gated_mix__softmax_full_mha__dense_activation_silu__prompt'

def setup_inputs():

    _w = (lambda a: (lambda t: t.to(torch.bfloat16) if t.is_floating_point() else t)(torch.as_tensor(a)))
    def _A_setup():
        B, S, D = 1, 2048, 448
        return {
            "x": _w((lambda *s: torch.randn(*s, dtype=torch.bfloat16) * 0.05)(B, S, D)),
            "wqkv": _w((lambda *s: torch.randn(*s, dtype=torch.bfloat16) * 0.8)(D, 3 * D)),
            "wo": _w((lambda *s: torch.randn(*s, dtype=torch.bfloat16) * 0.05)(D, D)),
        }
    _A_in = _A_setup()

    def _B_setup():
        B, S, D, F = 1, 2048, 448, 1792
        return {
            "x": _w((lambda *s: torch.randn(*s, dtype=torch.bfloat16) * 0.05)(B, S, D)),
            "w1": _w((lambda *s: torch.randn(*s, dtype=torch.bfloat16) * 3.2)(D, F) * (D ** -0.5)),
            "w2": _w((lambda *s: torch.randn(*s, dtype=torch.bfloat16) * 0.8)(F, D) * (F ** -0.5)),
        }
    _B_in = _B_setup()

    return {
        "A_x": _A_in["x"],
        "A_wqkv": _A_in["wqkv"],
        "A_wo": _A_in["wo"],
        "B_x": _B_in["x"],
        "B_w1": _B_in["w1"],
        "B_w2": _B_in["w2"],
        "gate_w": _w((lambda *s: torch.randn(*s, dtype=torch.bfloat16) * 0.05)(448) * 16.0),
    }

def reference(A_x, A_wqkv, A_wo, B_x, B_w1, B_w2, gate_w):
    def _A_ref(x, wqkv, wo):
        B, S, D = x.shape
        H = 16; Dh = D // H
        qkv = (lambda x, *d: x.permute(*d))((x @ wqkv).reshape(B, S, 3, H, Dh), 2, 0, 3, 1, 4)
        q, k, v = qkv[0], qkv[1], qkv[2]
        scale = Dh ** -0.5
        scores = torch.einsum("bhqd,bhkd->bhqk", q, k) * scale
        p = _softmax(scores, axis=-1)
        o = torch.einsum("bhqk,bhkd->bhqd", p, v)
        return (lambda x, *d: x.permute(*d))(o, 0, 2, 1, 3).reshape(B, S, D) @ wo

    def _B_ref(x, w1, w2):
        h = torch.einsum("bsd,df->bsf", x, w1)
        h = _silu(h)
        out = torch.einsum("bsf,fd->bsd", h, w2)
        return out

    x = A_x
    g = _sigmoid((x * gate_w).sum(-1, keepdims=True))
    a = _A_ref(x, A_wqkv, A_wo)
    b = _B_ref(x, B_w1, B_w2)
    return g * a + (1 - g) * b
```

```asm
; @launch grid=(256,1,1) block=(512,1,1) lds=163840
.amdgcn_target "amdgcn-amd-amdhsa--gfx950"
.text
.globl gated_mix__softmax_full_mha__dense_activation_silu__prompt_kernel
.p2align 8
.type gated_mix__softmax_full_mha__dense_activation_silu__prompt_kernel,@function
gated_mix__softmax_full_mha__dense_activation_silu__prompt_kernel:
  s_cmp_ge_u32 s2, 256
  s_cbranch_scc1 L_end

  s_load_dwordx16 s[64:79], s[0:1], 0
  s_load_dwordx4 s[80:83], s[0:1], 64
  v_lshrrev_b32 v5, 6, v0
  v_and_b32 v1, 63, v0
  v_readfirstlane_b32 s3, v5
  v_and_b32 v2, 31, v0
  v_bfe_u32 v3, v0, 5, 1
  v_lshlrev_b32 v4, 4, v1
  s_and_b32 s4, s2, 7
  s_lshr_b32 s5, s2, 3
  s_mul_i32 s10, s5, 37
  s_lshr_b32 s10, s10, 8
  s_mul_i32 s12, s10, 7
  s_sub_u32 s11, s5, s12
  s_lshr_b32 s12, s4, 1
  s_lshl_b32 s12, s12, 2
  s_add_u32 s6, s12, s10
  s_and_b32 s12, s4, 1
  s_mul_i32 s12, s12, 7
  s_add_u32 s7, s12, s11
  s_mov_b32 s52, 0
  s_mov_b32 s53, -1
  s_mov_b32 s54, -1
  s_mov_b32 s55, 0
  s_mov_b32 s56, 0x0fffffff
  s_mov_b32 s57, 0x0fffffff
  v_mov_b32 v5, 0
  s_waitcnt lgkmcnt(0)
  s_mov_b32 s44, s82
  s_and_b32 s45, s83, 0xffff
  s_mov_b32 s46, 19922944
  s_mov_b32 s47, 0x00020000
  buffer_load_dword v6, v5, s[44:47], 0 offen sc1
  s_mov_b32 s16, s64
  s_and_b32 s17, s65, 0xffff
  s_mov_b32 s18, 1835008
  s_mov_b32 s19, 0x00020000
  s_mov_b32 s20, s66
  s_and_b32 s21, s67, 0xffff
  s_mov_b32 s22, 1204224
  s_mov_b32 s23, 0x00020000
  s_mov_b32 s24, s68
  s_and_b32 s25, s69, 0xffff
  s_mov_b32 s26, 401408
  s_mov_b32 s27, 0x00020000
  s_mov_b32 s28, s72
  s_and_b32 s29, s73, 0xffff
  s_mov_b32 s30, 1605632
  s_mov_b32 s31, 0x00020000
  s_mov_b32 s32, s74
  s_and_b32 s33, s75, 0xffff
  s_mov_b32 s34, 1605632
  s_mov_b32 s35, 0x00020000
  s_mov_b32 s36, s76
  s_and_b32 s37, s77, 0xffff
  s_mov_b32 s38, 896
  s_mov_b32 s39, 0x00020000
  s_mov_b32 s40, s78
  s_and_b32 s41, s79, 0xffff
  s_mov_b32 s42, 1835008
  s_mov_b32 s43, 0x00020000
  s_mov_b32 s48, s80
  s_and_b32 s49, s81, 0xffff
  s_mov_b32 s50, 256
  s_mov_b32 s51, 0x00020000
  s_cmp_lg_u32 s3, 0
  s_cbranch_scc1 L_noinit
  v_lshlrev_b32 v7, 2, v1
  v_add_u32 v7, 159744, v7
  ds_write_b32 v7, v5
L_noinit:
  s_cmp_ge_u32 s5, 28
  s_cbranch_scc1 L_gate
  s_cmp_ge_u32 s3, 4
  s_cbranch_scc1 L_fwave
  s_lshl_b32 s76, s10, 1
  s_add_u32 s76, s76, s11
  s_sub_u32 s12, s76, 7
  s_cmp_ge_u32 s76, 7
  s_cselect_b32 s76, s12, s76
  s_lshl_b32 s77, s76, 7
  v_lshrrev_b32 v12, 3, v1
  s_lshl_b32 s12, s6, 7
  s_lshl_b32 s13, s3, 4
  s_add_u32 s12, s12, s13
  s_add_u32 s12, s12, 0
  v_add_u32 v12, s12, v12
  v_mul_u32_u24 v12, 896, v12
  v_lshrrev_b32 v13, 4, v1
  v_add_u32 v13, 0, v13
  v_and_b32 v14, 7, v1
  v_xor_b32 v13, v13, v14
  v_lshl_add_u32 v10, v13, 4, v12
  v_lshrrev_b32 v12, 3, v1
  s_lshl_b32 s12, s6, 7
  s_lshl_b32 s13, s3, 4
  s_add_u32 s12, s12, s13
  s_add_u32 s12, s12, 8
  v_add_u32 v12, s12, v12
  v_mul_u32_u24 v12, 896, v12
  v_lshrrev_b32 v13, 4, v1
  v_add_u32 v13, 4, v13
  v_and_b32 v14, 7, v1
  v_xor_b32 v13, v13, v14
  v_lshl_add_u32 v11, v13, 4, v12
  s_lshl_b32 s58, s3, 11
  s_add_u32 m0, s58, 0
  s_nop 0
  buffer_load_dwordx4 v10, s[16:19], s77 offen lds
  s_add_u32 m0, s58, 1024
  s_nop 0
  buffer_load_dwordx4 v11, s[16:19], s77 offen lds
  s_add_u32 s77, s77, 128
  s_cmp_ge_u32 s77, 896
  s_cselect_b32 s77, 0, s77
  s_barrier
  s_add_u32 m0, s58, 16384
  s_nop 0
  buffer_load_dwordx4 v10, s[16:19], s77 offen lds
  s_add_u32 m0, s58, 17408
  s_nop 0
  buffer_load_dwordx4 v11, s[16:19], s77 offen lds
  s_add_u32 s77, s77, 128
  s_cmp_ge_u32 s77, 896
  s_cselect_b32 s77, 0, s77
  s_add_u32 m0, s58, 32768
  s_nop 0
  buffer_load_dwordx4 v10, s[16:19], s77 offen lds
  s_add_u32 m0, s58, 33792
  s_nop 0
  buffer_load_dwordx4 v11, s[16:19], s77 offen lds
  s_add_u32 s77, s77, 128
  s_cmp_ge_u32 s77, 896
  s_cselect_b32 s77, 0, s77
  s_setprio 3
  s_and_b32 s12, s4, 1
  s_mul_i32 s64, s12, 2097152
  s_add_u32 s64, s64, 1048576
  s_lshl_b32 s65, 131072, s12
  s_lshl_b32 s66, 2048, s12
  s_cmp_eq_u32 s12, 0
  s_cselect_b32 s101, 1049335798, 1.0
  s_sub_u32 s100, s65, 1536
  s_lshl_b32 s67, s6, 2
  s_add_u32 s67, s67, s3
  s_mul_i32 s12, s67, s66
  s_add_u32 s64, s64, s12
  s_lshl_b32 s12, s11, 3
  s_add_u32 s12, s12, 0
  s_mul_i32 s13, s12, 37
  s_lshr_b32 s13, s13, 8
  s_mul_i32 s14, s13, 7
  s_sub_u32 s14, s12, s14
  s_lshl_b32 s13, s13, 1
  s_cmp_eq_u32 s14, 3
  s_cselect_b32 s92, -1, 0
  s_cmp_gt_u32 s14, 3
  s_cselect_b32 s15, 1, 0
  s_add_u32 s13, s13, s15
  s_mul_i32 s15, s15, 3
  s_sub_u32 s14, s14, s15
  s_mul_i32 s13, s13, s65
  s_lshl_b32 s14, s14, 9
  s_add_u32 s13, s13, s14
  s_add_u32 s84, s13, s64
  s_lshl_b32 s12, s11, 3
  s_add_u32 s12, s12, 1
  s_mul_i32 s13, s12, 37
  s_lshr_b32 s13, s13, 8
  s_mul_i32 s14, s13, 7
  s_sub_u32 s14, s12, s14
  s_lshl_b32 s13, s13, 1
  s_cmp_eq_u32 s14, 3
  s_cselect_b32 s93, -1, 0
  s_cmp_gt_u32 s14, 3
  s_cselect_b32 s15, 1, 0
  s_add_u32 s13, s13, s15
  s_mul_i32 s15, s15, 3
  s_sub_u32 s14, s14, s15
  s_mul_i32 s13, s13, s65
  s_lshl_b32 s14, s14, 9
  s_add_u32 s13, s13, s14
  s_add_u32 s85, s13, s64
  s_lshl_b32 s12, s11, 3
  s_add_u32 s12, s12, 2
  s_mul_i32 s13, s12, 37
  s_lshr_b32 s13, s13, 8
  s_mul_i32 s14, s13, 7
  s_sub_u32 s14, s12, s14
  s_lshl_b32 s13, s13, 1
  s_cmp_eq_u32 s14, 3
  s_cselect_b32 s94, -1, 0
  s_cmp_gt_u32 s14, 3
  s_cselect_b32 s15, 1, 0
  s_add_u32 s13, s13, s15
  s_mul_i32 s15, s15, 3
  s_sub_u32 s14, s14, s15
  s_mul_i32 s13, s13, s65
  s_lshl_b32 s14, s14, 9
  s_add_u32 s13, s13, s14
  s_add_u32 s86, s13, s64
  s_lshl_b32 s12, s11, 3
  s_add_u32 s12, s12, 3
  s_mul_i32 s13, s12, 37
  s_lshr_b32 s13, s13, 8
  s_mul_i32 s14, s13, 7
  s_sub_u32 s14, s12, s14
  s_lshl_b32 s13, s13, 1
  s_cmp_eq_u32 s14, 3
  s_cselect_b32 s95, -1, 0
  s_cmp_gt_u32 s14, 3
  s_cselect_b32 s15, 1, 0
  s_add_u32 s13, s13, s15
  s_mul_i32 s15, s15, 3
  s_sub_u32 s14, s14, s15
  s_mul_i32 s13, s13, s65
  s_lshl_b32 s14, s14, 9
  s_add_u32 s13, s13, s14
  s_add_u32 s87, s13, s64
  s_lshl_b32 s12, s11, 3
  s_add_u32 s12, s12, 4
  s_mul_i32 s13, s12, 37
  s_lshr_b32 s13, s13, 8
  s_mul_i32 s14, s13, 7
  s_sub_u32 s14, s12, s14
  s_lshl_b32 s13, s13, 1
  s_cmp_eq_u32 s14, 3
  s_cselect_b32 s96, -1, 0
  s_cmp_gt_u32 s14, 3
  s_cselect_b32 s15, 1, 0
  s_add_u32 s13, s13, s15
  s_mul_i32 s15, s15, 3
  s_sub_u32 s14, s14, s15
  s_mul_i32 s13, s13, s65
  s_lshl_b32 s14, s14, 9
  s_add_u32 s13, s13, s14
  s_add_u32 s88, s13, s64
  s_lshl_b32 s12, s11, 3
  s_add_u32 s12, s12, 5
  s_mul_i32 s13, s12, 37
  s_lshr_b32 s13, s13, 8
  s_mul_i32 s14, s13, 7
  s_sub_u32 s14, s12, s14
  s_lshl_b32 s13, s13, 1
  s_cmp_eq_u32 s14, 3
  s_cselect_b32 s97, -1, 0
  s_cmp_gt_u32 s14, 3
  s_cselect_b32 s15, 1, 0
  s_add_u32 s13, s13, s15
  s_mul_i32 s15, s15, 3
  s_sub_u32 s14, s14, s15
  s_mul_i32 s13, s13, s65
  s_lshl_b32 s14, s14, 9
  s_add_u32 s13, s13, s14
  s_add_u32 s89, s13, s64
  s_lshl_b32 s12, s11, 3
  s_add_u32 s12, s12, 6
  s_mul_i32 s13, s12, 37
  s_lshr_b32 s13, s13, 8
  s_mul_i32 s14, s13, 7
  s_sub_u32 s14, s12, s14
  s_lshl_b32 s13, s13, 1
  s_cmp_eq_u32 s14, 3
  s_cselect_b32 s98, -1, 0
  s_cmp_gt_u32 s14, 3
  s_cselect_b32 s15, 1, 0
  s_add_u32 s13, s13, s15
  s_mul_i32 s15, s15, 3
  s_sub_u32 s14, s14, s15
  s_mul_i32 s13, s13, s65
  s_lshl_b32 s14, s14, 9
  s_add_u32 s13, s13, s14
  s_add_u32 s90, s13, s64
  s_lshl_b32 s12, s11, 3
  s_add_u32 s12, s12, 7
  s_mul_i32 s13, s12, 37
  s_lshr_b32 s13, s13, 8
  s_mul_i32 s14, s13, 7
  s_sub_u32 s14, s12, s14
  s_lshl_b32 s13, s13, 1
  s_cmp_eq_u32 s14, 3
  s_cselect_b32 s99, -1, 0
  s_cmp_gt_u32 s14, 3
  s_cselect_b32 s15, 1, 0
  s_add_u32 s13, s13, s15
  s_mul_i32 s15, s15, 3
  s_sub_u32 s14, s14, s15
  s_mul_i32 s13, s13, s65
  s_lshl_b32 s14, s14, 9
  s_add_u32 s13, s13, s14
  s_add_u32 s91, s13, s64
  v_bfe_u32 v12, v2, 1, 3
  s_lshl_b32 s12, s3, 12
  v_lshl_add_u32 v13, v2, 7, s12
  v_add_u32 v14, 0, v3
  v_xor_b32 v14, v14, v12
  v_lshl_add_u32 v16, v14, 4, v13
  v_add_u32 v14, 2, v3
  v_xor_b32 v14, v14, v12
  v_lshl_add_u32 v17, v14, 4, v13
  v_add_u32 v14, 4, v3
  v_xor_b32 v14, v14, v12
  v_lshl_add_u32 v18, v14, 4, v13
  v_add_u32 v14, 6, v3
  v_xor_b32 v14, v14, v12
  v_lshl_add_u32 v19, v14, 4, v13
  v_bfe_u32 v12, v1, 2, 2
  v_lshl_add_u32 v12, v3, 3, v12
  v_mul_u32_u24 v12, 192, v12
  v_bfe_u32 v13, v1, 4, 1
  v_lshl_add_u32 v12, v13, 5, v12
  v_and_b32 v13, 3, v1
  v_lshl_add_u32 v12, v13, 3, v12
  v_add_u32 v20, 98304, v12
  s_lshl_b32 s12, s7, 5
  v_add_u32 v12, s12, v2
  v_mul_u32_u24 v13, 2341, v12
  v_lshrrev_b32 v13, 16, v13
  v_mul_u32_u24 v14, 28, v13
  v_sub_u32 v12, v12, v14
  v_lshl_add_u32 v12, v3, 5, v12
  v_lshlrev_b32 v12, 4, v12
  v_lshl_add_u32 v12, v13, 18, v12
  s_lshl_b32 s12, s67, 12
  s_add_u32 s12, s12, 3145728
  v_add_u32 v21, s12, v12
  v_lshlrev_b32 v22, 4, v2
  s_mov_b32 s82, s101
  s_mov_b32 s83, s101
  s_bitcmp1_b32 s4, 0
  s_cselect_b32 s79, 0x3F803F80, 0
  v_mov_b32 v24, s84
  s_mov_b64 exec, s[52:53]
  v_mov_b32 v24, s85
  s_mov_b64 exec, -1
  v_add_u32 v24, v24, v22
  v_mov_b32 v40, s79
  v_mov_b32 v41, s79
  v_mov_b32 v42, 0
  v_mov_b32 v43, 0
  v_mov_b32 v25, s86
  s_mov_b64 exec, s[52:53]
  v_mov_b32 v25, s87
  s_mov_b64 exec, -1
  v_add_u32 v25, v25, v22
  v_mov_b32 v44, s79
  v_mov_b32 v45, s79
  v_mov_b32 v46, 0
  v_mov_b32 v47, 0
  v_mov_b32 v26, s88
  s_mov_b64 exec, s[52:53]
  v_mov_b32 v26, s89
  s_mov_b64 exec, -1
  v_add_u32 v26, v26, v22
  v_mov_b32 v48, s79
  v_mov_b32 v49, s79
  v_mov_b32 v50, 0
  v_mov_b32 v51, 0
  v_mov_b32 v27, s90
  s_mov_b64 exec, s[52:53]
  v_mov_b32 v27, s91
  s_mov_b64 exec, -1
  v_add_u32 v27, v27, v22
  v_mov_b32 v52, s79
  v_mov_b32 v53, s79
  v_mov_b32 v54, 0
  v_mov_b32 v55, 0
  s_waitcnt vmcnt(4) lgkmcnt(0)
  v_readfirstlane_b32 s9, v6
  s_nop 0
  s_mul_i32 s8, s9, 0x9E3779B1
  s_xor_b32 s8, s8, 0x5bd1e995
  s_barrier
  ds_read_b128 v[128:131], v16 offset:0
  ds_read_b64_tr_b16 v[28:29], v20 offset:36864
  ds_read_b64_tr_b16 v[30:31], v20 offset:37632
  ds_read_b64_tr_b16 v[32:33], v20 offset:36928
  ds_read_b64_tr_b16 v[34:35], v20 offset:37696
  ds_read_b64_tr_b16 v[36:37], v20 offset:36992
  ds_read_b64_tr_b16 v[38:39], v20 offset:37760
  ds_read_b128 v[132:135], v17 offset:0
  ds_read_b64_tr_b16 v[112:113], v20 offset:39936
  ds_read_b64_tr_b16 v[114:115], v20 offset:40704
  ds_read_b64_tr_b16 v[116:117], v20 offset:40000
  ds_read_b64_tr_b16 v[118:119], v20 offset:40768
  ds_read_b64_tr_b16 v[120:121], v20 offset:40064
  ds_read_b64_tr_b16 v[122:123], v20 offset:40832
  s_add_u32 m0, s58, 49152
  s_nop 0
  buffer_load_dwordx4 v10, s[16:19], s77 offen lds
  s_add_u32 m0, s58, 50176
  s_nop 0
  buffer_load_dwordx4 v11, s[16:19], s77 offen lds
  s_add_u32 s77, s77, 128
  s_cmp_ge_u32 s77, 896
  s_cselect_b32 s77, 0, s77
  s_add_u32 m0, s58, 65536
  s_nop 0
  buffer_load_dwordx4 v10, s[16:19], s77 offen lds
  s_add_u32 m0, s58, 66560
  s_nop 0
  buffer_load_dwordx4 v11, s[16:19], s77 offen lds
  s_add_u32 s77, s77, 128
  s_cmp_ge_u32 s77, 896
  s_cselect_b32 s77, 0, s77
  s_add_u32 m0, s58, 81920
  s_nop 0
  buffer_load_dwordx4 v10, s[16:19], s77 offen lds
  s_add_u32 m0, s58, 82944
  s_nop 0
  buffer_load_dwordx4 v11, s[16:19], s77 offen lds
  s_add_u32 s77, s77, 128
  s_cmp_ge_u32 s77, 896
  s_cselect_b32 s77, 0, s77
  s_waitcnt lgkmcnt(7)
  v_mfma_f32_32x32x16_bf16 v[96:111], v[128:131], v[36:39], 0
  v_mfma_f32_32x32x16_bf16 v[64:79], v[28:31], v[128:131], 0
  v_mfma_f32_32x32x16_bf16 v[80:95], v[32:35], v[128:131], 0
  ds_read_b128 v[136:139], v18 offset:0
  ds_read_b64_tr_b16 v[240:241], v20 offset:43008
  ds_read_b64_tr_b16 v[242:243], v20 offset:43776
  ds_read_b64_tr_b16 v[244:245], v20 offset:43072
  ds_read_b64_tr_b16 v[246:247], v20 offset:43840
  ds_read_b64_tr_b16 v[248:249], v20 offset:43136
  ds_read_b64_tr_b16 v[250:251], v20 offset:43904
  s_waitcnt lgkmcnt(7)
  v_mfma_f32_32x32x16_bf16 v[96:111], v[132:135], v[120:123], v[96:111]
  v_mfma_f32_32x32x16_bf16 v[64:79], v[112:115], v[132:135], v[64:79]
  v_mfma_f32_32x32x16_bf16 v[80:95], v[116:119], v[132:135], v[80:95]
  ds_read_b128 v[140:143], v19 offset:0
  ds_read_b64_tr_b16 v[56:57], v20 offset:46080
  ds_read_b64_tr_b16 v[58:59], v20 offset:46848
  ds_read_b64_tr_b16 v[60:61], v20 offset:46144
  ds_read_b64_tr_b16 v[62:63], v20 offset:46912
  ds_read_b64_tr_b16 v[124:125], v20 offset:46208
  ds_read_b64_tr_b16 v[126:127], v20 offset:46976
  s_waitcnt vmcnt(8) lgkmcnt(0)
  s_barrier
  ds_read_b128 v[144:147], v16 offset:16384
  ds_read_b64_tr_b16 v[28:29], v20 offset:49152
  ds_read_b64_tr_b16 v[30:31], v20 offset:49920
  ds_read_b64_tr_b16 v[32:33], v20 offset:49216
  ds_read_b64_tr_b16 v[34:35], v20 offset:49984
  ds_read_b64_tr_b16 v[36:37], v20 offset:49280
  ds_read_b64_tr_b16 v[38:39], v20 offset:50048
  ds_read_b128 v[148:151], v17 offset:16384
  ds_read_b64_tr_b16 v[112:113], v20 offset:52224
  ds_read_b64_tr_b16 v[114:115], v20 offset:52992
  ds_read_b64_tr_b16 v[116:117], v20 offset:52288
  ds_read_b64_tr_b16 v[118:119], v20 offset:53056
  ds_read_b64_tr_b16 v[120:121], v20 offset:52352
  ds_read_b64_tr_b16 v[122:123], v20 offset:53120
  s_add_u32 m0, s58, 0
  s_nop 0
  buffer_load_dwordx4 v10, s[16:19], s77 offen lds
  s_add_u32 m0, s58, 1024
  s_nop 0
  buffer_load_dwordx4 v11, s[16:19], s77 offen lds
  s_add_u32 s77, s77, 128
  s_cmp_ge_u32 s77, 896
  s_cselect_b32 s77, 0, s77
  v_mfma_f32_32x32x16_bf16 v[96:111], v[136:139], v[248:251], v[96:111]
  v_mfma_f32_32x32x16_bf16 v[64:79], v[240:243], v[136:139], v[64:79]
  v_mfma_f32_32x32x16_bf16 v[80:95], v[244:247], v[136:139], v[80:95]
  v_mfma_f32_32x32x16_bf16 v[96:111], v[140:143], v[124:127], v[96:111]
  v_mfma_f32_32x32x16_bf16 v[64:79], v[56:59], v[140:143], v[64:79]
  v_mfma_f32_32x32x16_bf16 v[80:95], v[60:63], v[140:143], v[80:95]
  s_waitcnt lgkmcnt(7)
  v_mfma_f32_32x32x16_bf16 v[96:111], v[144:147], v[36:39], v[96:111]
  v_mfma_f32_32x32x16_bf16 v[64:79], v[28:31], v[144:147], v[64:79]
  v_mfma_f32_32x32x16_bf16 v[80:95], v[32:35], v[144:147], v[80:95]
  ds_read_b128 v[152:155], v18 offset:16384
  ds_read_b64_tr_b16 v[240:241], v20 offset:55296
  ds_read_b64_tr_b16 v[242:243], v20 offset:56064
  ds_read_b64_tr_b16 v[244:245], v20 offset:55360
  ds_read_b64_tr_b16 v[246:247], v20 offset:56128
  ds_read_b64_tr_b16 v[248:249], v20 offset:55424
  ds_read_b64_tr_b16 v[250:251], v20 offset:56192
  s_waitcnt lgkmcnt(7)
  v_mfma_f32_32x32x16_bf16 v[96:111], v[148:151], v[120:123], v[96:111]
  v_mfma_f32_32x32x16_bf16 v[64:79], v[112:115], v[148:151], v[64:79]
  v_mfma_f32_32x32x16_bf16 v[80:95], v[116:119], v[148:151], v[80:95]
  ds_read_b128 v[156:159], v19 offset:16384
  ds_read_b64_tr_b16 v[56:57], v20 offset:58368
  ds_read_b64_tr_b16 v[58:59], v20 offset:59136
  ds_read_b64_tr_b16 v[60:61], v20 offset:58432
  ds_read_b64_tr_b16 v[62:63], v20 offset:59200
  ds_read_b64_tr_b16 v[124:125], v20 offset:58496
  ds_read_b64_tr_b16 v[126:127], v20 offset:59264
  s_waitcnt vmcnt(8) lgkmcnt(0)
  s_barrier
  ds_read_b128 v[160:163], v16 offset:32768
  ds_read_b64_tr_b16 v[28:29], v20 offset:0
  ds_read_b64_tr_b16 v[30:31], v20 offset:768
  ds_read_b64_tr_b16 v[32:33], v20 offset:64
  ds_read_b64_tr_b16 v[34:35], v20 offset:832
  ds_read_b64_tr_b16 v[36:37], v20 offset:128
  ds_read_b64_tr_b16 v[38:39], v20 offset:896
  ds_read_b128 v[164:167], v17 offset:32768
  ds_read_b64_tr_b16 v[112:113], v20 offset:3072
  ds_read_b64_tr_b16 v[114:115], v20 offset:3840
  ds_read_b64_tr_b16 v[116:117], v20 offset:3136
  ds_read_b64_tr_b16 v[118:119], v20 offset:3904
  ds_read_b64_tr_b16 v[120:121], v20 offset:3200
  ds_read_b64_tr_b16 v[122:123], v20 offset:3968
  v_mfma_f32_32x32x16_bf16 v[96:111], v[152:155], v[248:251], v[96:111]
  v_mfma_f32_32x32x16_bf16 v[64:79], v[240:243], v[152:155], v[64:79]
  v_mfma_f32_32x32x16_bf16 v[80:95], v[244:247], v[152:155], v[80:95]
  v_mfma_f32_32x32x16_bf16 v[96:111], v[156:159], v[124:127], v[96:111]
  v_mfma_f32_32x32x16_bf16 v[64:79], v[56:59], v[156:159], v[64:79]
  v_mfma_f32_32x32x16_bf16 v[80:95], v[60:63], v[156:159], v[80:95]
  s_waitcnt lgkmcnt(7)
  v_mfma_f32_32x32x16_bf16 v[96:111], v[160:163], v[36:39], v[96:111]
  v_mfma_f32_32x32x16_bf16 v[64:79], v[28:31], v[160:163], v[64:79]
  v_mfma_f32_32x32x16_bf16 v[80:95], v[32:35], v[160:163], v[80:95]
  ds_read_b128 v[168:171], v18 offset:32768
  ds_read_b64_tr_b16 v[240:241], v20 offset:6144
  ds_read_b64_tr_b16 v[242:243], v20 offset:6912
  ds_read_b64_tr_b16 v[244:245], v20 offset:6208
  ds_read_b64_tr_b16 v[246:247], v20 offset:6976
  ds_read_b64_tr_b16 v[248:249], v20 offset:6272
  ds_read_b64_tr_b16 v[250:251], v20 offset:7040
  s_waitcnt lgkmcnt(7)
  v_mfma_f32_32x32x16_bf16 v[96:111], v[164:167], v[120:123], v[96:111]
  v_mfma_f32_32x32x16_bf16 v[64:79], v[112:115], v[164:167], v[64:79]
  v_mfma_f32_32x32x16_bf16 v[80:95], v[116:119], v[164:167], v[80:95]
  ds_read_b128 v[172:175], v19 offset:32768
  ds_read_b64_tr_b16 v[56:57], v20 offset:9216
  ds_read_b64_tr_b16 v[58:59], v20 offset:9984
  ds_read_b64_tr_b16 v[60:61], v20 offset:9280
  ds_read_b64_tr_b16 v[62:63], v20 offset:10048
  ds_read_b64_tr_b16 v[124:125], v20 offset:9344
  ds_read_b64_tr_b16 v[126:127], v20 offset:10112
  s_waitcnt vmcnt(6) lgkmcnt(0)
  s_barrier
  ds_read_b128 v[176:179], v16 offset:49152
  ds_read_b64_tr_b16 v[28:29], v20 offset:12288
  ds_read_b64_tr_b16 v[30:31], v20 offset:13056
  ds_read_b64_tr_b16 v[32:33], v20 offset:12352
  ds_read_b64_tr_b16 v[34:35], v20 offset:13120
  ds_read_b64_tr_b16 v[36:37], v20 offset:12416
  ds_read_b64_tr_b16 v[38:39], v20 offset:13184
  ds_read_b128 v[180:183], v17 offset:49152
  ds_read_b64_tr_b16 v[112:113], v20 offset:15360
  ds_read_b64_tr_b16 v[114:115], v20 offset:16128
  ds_read_b64_tr_b16 v[116:117], v20 offset:15424
  ds_read_b64_tr_b16 v[118:119], v20 offset:16192
  ds_read_b64_tr_b16 v[120:121], v20 offset:15488
  ds_read_b64_tr_b16 v[122:123], v20 offset:16256
  v_mfma_f32_32x32x16_bf16 v[96:111], v[168:171], v[248:251], v[96:111]
  v_mfma_f32_32x32x16_bf16 v[64:79], v[240:243], v[168:171], v[64:79]
  v_mfma_f32_32x32x16_bf16 v[80:95], v[244:247], v[168:171], v[80:95]
  v_mfma_f32_32x32x16_bf16 v[96:111], v[172:175], v[124:127], v[96:111]
  v_mfma_f32_32x32x16_bf16 v[64:79], v[56:59], v[172:175], v[64:79]
  v_mfma_f32_32x32x16_bf16 v[80:95], v[60:63], v[172:175], v[80:95]
  s_waitcnt lgkmcnt(7)
  v_mfma_f32_32x32x16_bf16 v[96:111], v[176:179], v[36:39], v[96:111]
  v_mfma_f32_32x32x16_bf16 v[64:79], v[28:31], v[176:179], v[64:79]
  v_mfma_f32_32x32x16_bf16 v[80:95], v[32:35], v[176:179], v[80:95]
  ds_read_b128 v[184:187], v18 offset:49152
  ds_read_b64_tr_b16 v[240:241], v20 offset:18432
  ds_read_b64_tr_b16 v[242:243], v20 offset:19200
  ds_read_b64_tr_b16 v[244:245], v20 offset:18496
  ds_read_b64_tr_b16 v[246:247], v20 offset:19264
  ds_read_b64_tr_b16 v[248:249], v20 offset:18560
  ds_read_b64_tr_b16 v[250:251], v20 offset:19328
  s_waitcnt lgkmcnt(7)
  v_mfma_f32_32x32x16_bf16 v[96:111], v[180:183], v[120:123], v[96:111]
  v_mfma_f32_32x32x16_bf16 v[64:79], v[112:115], v[180:183], v[64:79]
  v_mfma_f32_32x32x16_bf16 v[80:95], v[116:119], v[180:183], v[80:95]
  ds_read_b128 v[188:191], v19 offset:49152
  ds_read_b64_tr_b16 v[56:57], v20 offset:21504
  ds_read_b64_tr_b16 v[58:59], v20 offset:22272
  ds_read_b64_tr_b16 v[60:61], v20 offset:21568
  ds_read_b64_tr_b16 v[62:63], v20 offset:22336
  ds_read_b64_tr_b16 v[124:125], v20 offset:21632
  ds_read_b64_tr_b16 v[126:127], v20 offset:22400
  s_waitcnt vmcnt(4) lgkmcnt(0)
  s_barrier
  v_add_u32 v16, 0x10000, v16
  v_add_u32 v17, 0x10000, v17
  v_add_u32 v18, 0x10000, v18
  v_add_u32 v19, 0x10000, v19
  ds_read_b128 v[192:195], v16 offset:0
  ds_read_b64_tr_b16 v[28:29], v20 offset:24576
  ds_read_b64_tr_b16 v[30:31], v20 offset:25344
  ds_read_b64_tr_b16 v[32:33], v20 offset:24640
  ds_read_b64_tr_b16 v[34:35], v20 offset:25408
  ds_read_b64_tr_b16 v[36:37], v20 offset:24704
  ds_read_b64_tr_b16 v[38:39], v20 offset:25472
  ds_read_b128 v[196:199], v17 offset:0
  ds_read_b64_tr_b16 v[112:113], v20 offset:27648
  ds_read_b64_tr_b16 v[114:115], v20 offset:28416
  ds_read_b64_tr_b16 v[116:117], v20 offset:27712
  ds_read_b64_tr_b16 v[118:119], v20 offset:28480
  ds_read_b64_tr_b16 v[120:121], v20 offset:27776
  ds_read_b64_tr_b16 v[122:123], v20 offset:28544
  v_mfma_f32_32x32x16_bf16 v[96:111], v[184:187], v[248:251], v[96:111]
  v_mfma_f32_32x32x16_bf16 v[64:79], v[240:243], v[184:187], v[64:79]
  v_mfma_f32_32x32x16_bf16 v[80:95], v[244:247], v[184:187], v[80:95]
  v_mfma_f32_32x32x16_bf16 v[96:111], v[188:191], v[124:127], v[96:111]
  v_mfma_f32_32x32x16_bf16 v[64:79], v[56:59], v[188:191], v[64:79]
  v_mfma_f32_32x32x16_bf16 v[80:95], v[60:63], v[188:191], v[80:95]
  s_waitcnt lgkmcnt(7)
  v_mfma_f32_32x32x16_bf16 v[96:111], v[192:195], v[36:39], v[96:111]
  v_mfma_f32_32x32x16_bf16 v[64:79], v[28:31], v[192:195], v[64:79]
  v_mfma_f32_32x32x16_bf16 v[80:95], v[32:35], v[192:195], v[80:95]
  ds_read_b128 v[200:203], v18 offset:0
  ds_read_b64_tr_b16 v[240:241], v20 offset:30720
  ds_read_b64_tr_b16 v[242:243], v20 offset:31488
  ds_read_b64_tr_b16 v[244:245], v20 offset:30784
  ds_read_b64_tr_b16 v[246:247], v20 offset:31552
  ds_read_b64_tr_b16 v[248:249], v20 offset:30848
  ds_read_b64_tr_b16 v[250:251], v20 offset:31616
  s_waitcnt lgkmcnt(7)
  v_mfma_f32_32x32x16_bf16 v[96:111], v[196:199], v[120:123], v[96:111]
  v_mfma_f32_32x32x16_bf16 v[64:79], v[112:115], v[196:199], v[64:79]
  v_mfma_f32_32x32x16_bf16 v[80:95], v[116:119], v[196:199], v[80:95]
  ds_read_b128 v[204:207], v19 offset:0
  ds_read_b64_tr_b16 v[56:57], v20 offset:33792
  ds_read_b64_tr_b16 v[58:59], v20 offset:34560
  ds_read_b64_tr_b16 v[60:61], v20 offset:33856
  ds_read_b64_tr_b16 v[62:63], v20 offset:34624
  ds_read_b64_tr_b16 v[124:125], v20 offset:33920
  ds_read_b64_tr_b16 v[126:127], v20 offset:34688
  s_waitcnt vmcnt(2) lgkmcnt(0)
  s_barrier
  ds_read_b128 v[208:211], v16 offset:16384
  ds_read_b64_tr_b16 v[28:29], v20 offset:36864
  ds_read_b64_tr_b16 v[30:31], v20 offset:37632
  ds_read_b64_tr_b16 v[32:33], v20 offset:36928
  ds_read_b64_tr_b16 v[34:35], v20 offset:37696
  ds_read_b64_tr_b16 v[36:37], v20 offset:36992
  ds_read_b64_tr_b16 v[38:39], v20 offset:37760
  ds_read_b128 v[212:215], v17 offset:16384
  ds_read_b64_tr_b16 v[112:113], v20 offset:39936
  ds_read_b64_tr_b16 v[114:115], v20 offset:40704
  ds_read_b64_tr_b16 v[116:117], v20 offset:40000
  ds_read_b64_tr_b16 v[118:119], v20 offset:40768
  ds_read_b64_tr_b16 v[120:121], v20 offset:40064
  ds_read_b64_tr_b16 v[122:123], v20 offset:40832
  v_mfma_f32_32x32x16_bf16 v[96:111], v[200:203], v[248:251], v[96:111]
  v_mfma_f32_32x32x16_bf16 v[64:79], v[240:243], v[200:203], v[64:79]
  v_mfma_f32_32x32x16_bf16 v[80:95], v[244:247], v[200:203], v[80:95]
  v_mfma_f32_32x32x16_bf16 v[96:111], v[204:207], v[124:127], v[96:111]
  v_mfma_f32_32x32x16_bf16 v[64:79], v[56:59], v[204:207], v[64:79]
  v_mfma_f32_32x32x16_bf16 v[80:95], v[60:63], v[204:207], v[80:95]
  s_waitcnt lgkmcnt(7)
  v_mfma_f32_32x32x16_bf16 v[96:111], v[208:211], v[36:39], v[96:111]
  v_mfma_f32_32x32x16_bf16 v[64:79], v[28:31], v[208:211], v[64:79]
  v_mfma_f32_32x32x16_bf16 v[80:95], v[32:35], v[208:211], v[80:95]
  ds_read_b128 v[216:219], v18 offset:16384
  ds_read_b64_tr_b16 v[240:241], v20 offset:43008
  ds_read_b64_tr_b16 v[242:243], v20 offset:43776
  ds_read_b64_tr_b16 v[244:245], v20 offset:43072
  ds_read_b64_tr_b16 v[246:247], v20 offset:43840
  ds_read_b64_tr_b16 v[248:249], v20 offset:43136
  ds_read_b64_tr_b16 v[250:251], v20 offset:43904
  s_waitcnt lgkmcnt(7)
  v_mfma_f32_32x32x16_bf16 v[96:111], v[212:215], v[120:123], v[96:111]
  v_mfma_f32_32x32x16_bf16 v[64:79], v[112:115], v[212:215], v[64:79]
  v_mfma_f32_32x32x16_bf16 v[80:95], v[116:119], v[212:215], v[80:95]
  ds_read_b128 v[220:223], v19 offset:16384
  ds_read_b64_tr_b16 v[56:57], v20 offset:46080
  ds_read_b64_tr_b16 v[58:59], v20 offset:46848
  ds_read_b64_tr_b16 v[60:61], v20 offset:46144
  ds_read_b64_tr_b16 v[62:63], v20 offset:46912
  ds_read_b64_tr_b16 v[124:125], v20 offset:46208
  ds_read_b64_tr_b16 v[126:127], v20 offset:46976
  s_waitcnt vmcnt(0) lgkmcnt(0)
  s_barrier
  v_subrev_u32 v16, 0x10000, v16
  v_subrev_u32 v17, 0x10000, v17
  v_subrev_u32 v18, 0x10000, v18
  v_subrev_u32 v19, 0x10000, v19
  ds_read_b128 v[224:227], v16 offset:0
  ds_read_b64_tr_b16 v[28:29], v20 offset:49152
  ds_read_b64_tr_b16 v[30:31], v20 offset:49920
  ds_read_b64_tr_b16 v[32:33], v20 offset:49216
  ds_read_b64_tr_b16 v[34:35], v20 offset:49984
  ds_read_b64_tr_b16 v[36:37], v20 offset:49280
  ds_read_b64_tr_b16 v[38:39], v20 offset:50048
  ds_read_b128 v[228:231], v17 offset:0
  ds_read_b64_tr_b16 v[112:113], v20 offset:52224
  ds_read_b64_tr_b16 v[114:115], v20 offset:52992
  ds_read_b64_tr_b16 v[116:117], v20 offset:52288
  ds_read_b64_tr_b16 v[118:119], v20 offset:53056
  ds_read_b64_tr_b16 v[120:121], v20 offset:52352
  ds_read_b64_tr_b16 v[122:123], v20 offset:53120
  v_mfma_f32_32x32x16_bf16 v[96:111], v[216:219], v[248:251], v[96:111]
  v_mfma_f32_32x32x16_bf16 v[64:79], v[240:243], v[216:219], v[64:79]
  v_mfma_f32_32x32x16_bf16 v[80:95], v[244:247], v[216:219], v[80:95]
  v_mfma_f32_32x32x16_bf16 v[96:111], v[220:223], v[124:127], v[96:111]
  v_mfma_f32_32x32x16_bf16 v[64:79], v[56:59], v[220:223], v[64:79]
  v_mfma_f32_32x32x16_bf16 v[80:95], v[60:63], v[220:223], v[80:95]
  s_waitcnt lgkmcnt(7)
  v_mfma_f32_32x32x16_bf16 v[96:111], v[224:227], v[36:39], v[96:111]
  v_mfma_f32_32x32x16_bf16 v[64:79], v[28:31], v[224:227], v[64:79]
  v_mfma_f32_32x32x16_bf16 v[80:95], v[32:35], v[224:227], v[80:95]
  ds_read_b128 v[232:235], v18 offset:0
  ds_read_b64_tr_b16 v[240:241], v20 offset:55296
  ds_read_b64_tr_b16 v[242:243], v20 offset:56064
  ds_read_b64_tr_b16 v[244:245], v20 offset:55360
  ds_read_b64_tr_b16 v[246:247], v20 offset:56128
  ds_read_b64_tr_b16 v[248:249], v20 offset:55424
  ds_read_b64_tr_b16 v[250:251], v20 offset:56192
  s_waitcnt lgkmcnt(7)
  v_mfma_f32_32x32x16_bf16 v[96:111], v[228:231], v[120:123], v[96:111]
  v_mfma_f32_32x32x16_bf16 v[64:79], v[112:115], v[228:231], v[64:79]
  v_mfma_f32_32x32x16_bf16 v[80:95], v[116:119], v[228:231], v[80:95]
  ds_read_b128 v[236:239], v19 offset:0
  ds_read_b64_tr_b16 v[56:57], v20 offset:58368
  ds_read_b64_tr_b16 v[58:59], v20 offset:59136
  ds_read_b64_tr_b16 v[60:61], v20 offset:58432
  ds_read_b64_tr_b16 v[62:63], v20 offset:59200
  ds_read_b64_tr_b16 v[124:125], v20 offset:58496
  ds_read_b64_tr_b16 v[126:127], v20 offset:59264
  s_waitcnt lgkmcnt(0)
  v_mfma_f32_32x32x16_bf16 v[96:111], v[232:235], v[248:251], v[96:111]
  v_mfma_f32_32x32x16_bf16 v[64:79], v[240:243], v[232:235], v[64:79]
  v_mfma_f32_32x32x16_bf16 v[80:95], v[244:247], v[232:235], v[80:95]
  v_mfma_f32_32x32x16_bf16 v[96:111], v[236:239], v[124:127], v[96:111]
  v_mfma_f32_32x32x16_bf16 v[64:79], v[56:59], v[236:239], v[64:79]
  v_mfma_f32_32x32x16_bf16 v[80:95], v[60:63], v[236:239], v[80:95]
  v_mov_b32 v12, 159764
  v_mov_b32 v13, 1
  s_mov_b64 exec, 1
  ds_add_u32 v12, v13
  s_mov_b64 exec, -1
  s_nop 4
  v_cvt_pk_bf16_f32 v28, v96, v97
  v_cvt_pk_bf16_f32 v29, v98, v99
  v_cvt_pk_bf16_f32 v30, v100, v101
  v_cvt_pk_bf16_f32 v31, v102, v103
  v_cvt_pk_bf16_f32 v32, v104, v105
  v_cvt_pk_bf16_f32 v33, v106, v107
  v_cvt_pk_bf16_f32 v34, v108, v109
  v_cvt_pk_bf16_f32 v35, v110, v111
  buffer_store_dwordx4 v[28:31], v21, s[44:47], 0 offen offset:2048 sc1
  buffer_store_dwordx4 v[32:35], v21, s[44:47], 0 offen offset:3072 sc1
  s_bitcmp1_b32 s4, 0
  s_cbranch_scc1 L_noscale
  v_pk_mul_f32 v[64:65], v[64:65], s[82:83]
  v_pk_mul_f32 v[66:67], v[66:67], s[82:83]
  v_pk_mul_f32 v[68:69], v[68:69], s[82:83]
  v_pk_mul_f32 v[70:71], v[70:71], s[82:83]
  v_pk_mul_f32 v[72:73], v[72:73], s[82:83]
  v_pk_mul_f32 v[74:75], v[74:75], s[82:83]
  v_pk_mul_f32 v[76:77], v[76:77], s[82:83]
  v_pk_mul_f32 v[78:79], v[78:79], s[82:83]
  v_pk_mul_f32 v[80:81], v[80:81], s[82:83]
  v_pk_mul_f32 v[82:83], v[82:83], s[82:83]
  v_pk_mul_f32 v[84:85], v[84:85], s[82:83]
  v_pk_mul_f32 v[86:87], v[86:87], s[82:83]
  v_pk_mul_f32 v[88:89], v[88:89], s[82:83]
  v_pk_mul_f32 v[90:91], v[90:91], s[82:83]
  v_pk_mul_f32 v[92:93], v[92:93], s[82:83]
  v_pk_mul_f32 v[94:95], v[94:95], s[82:83]
L_noscale:
  v_cvt_pk_bf16_f32 v112, v64, v65
  v_cvt_pk_bf16_f32 v113, v66, v67
  v_cvt_pk_bf16_f32 v114, v68, v69
  v_cvt_pk_bf16_f32 v115, v70, v71
  v_cvt_pk_bf16_f32 v116, v72, v73
  v_cvt_pk_bf16_f32 v117, v74, v75
  v_cvt_pk_bf16_f32 v118, v76, v77
  v_cvt_pk_bf16_f32 v119, v78, v79
  v_permlane32_swap_b32 v112, v114
  v_permlane32_swap_b32 v113, v115
  v_permlane32_swap_b32 v116, v118
  v_permlane32_swap_b32 v117, v119
  s_mov_b64 exec, s[92:93]
  s_cbranch_execz L_nosplit0
  v_mov_b32 v42, v114
  v_mov_b32 v43, v115
  v_mov_b32 v114, s79
  v_mov_b32 v115, s79
  buffer_store_dwordx4 v[40:43], v24, s[44:47], s100 offen sc1
L_nosplit0:
  s_mov_b64 exec, -1
  buffer_store_dwordx4 v[112:115], v24, s[44:47], 0 offen sc1
  s_mov_b64 exec, s[94:95]
  s_cbranch_execz L_nosplit1
  v_mov_b32 v46, v118
  v_mov_b32 v47, v119
  v_mov_b32 v118, s79
  v_mov_b32 v119, s79
  buffer_store_dwordx4 v[44:47], v25, s[44:47], s100 offen sc1
L_nosplit1:
  s_mov_b64 exec, -1
  buffer_store_dwordx4 v[116:119], v25, s[44:47], 0 offen sc1
  v_cvt_pk_bf16_f32 v240, v80, v81
  v_cvt_pk_bf16_f32 v241, v82, v83
  v_cvt_pk_bf16_f32 v242, v84, v85
  v_cvt_pk_bf16_f32 v243, v86, v87
  v_cvt_pk_bf16_f32 v244, v88, v89
  v_cvt_pk_bf16_f32 v245, v90, v91
  v_cvt_pk_bf16_f32 v246, v92, v93
  v_cvt_pk_bf16_f32 v247, v94, v95
  v_permlane32_swap_b32 v240, v242
  v_permlane32_swap_b32 v241, v243
  v_permlane32_swap_b32 v244, v246
  v_permlane32_swap_b32 v245, v247
  s_mov_b64 exec, s[96:97]
  s_cbranch_execz L_nosplit2
  v_mov_b32 v50, v242
  v_mov_b32 v51, v243
  v_mov_b32 v242, s79
  v_mov_b32 v243, s79
  buffer_store_dwordx4 v[48:51], v26, s[44:47], s100 offen sc1
L_nosplit2:
  s_mov_b64 exec, -1
  buffer_store_dwordx4 v[240:243], v26, s[44:47], 0 offen sc1
  s_mov_b64 exec, s[98:99]
  s_cbranch_execz L_nosplit3
  v_mov_b32 v54, v246
  v_mov_b32 v55, v247
  v_mov_b32 v246, s79
  v_mov_b32 v247, s79
  buffer_store_dwordx4 v[52:55], v27, s[44:47], s100 offen sc1
L_nosplit3:
  s_mov_b64 exec, -1
  buffer_store_dwordx4 v[244:247], v27, s[44:47], 0 offen sc1
  s_lshl_b32 s12, s7, 4
  s_add_u32 s12, s12, s6
  s_lshl_b32 s12, s12, 7
  s_add_u32 s14, s12, 65536
  v_mov_b32 v12, 159776
  v_mov_b32 v13, 1
  s_waitcnt vmcnt(0)
  s_mov_b64 exec, 1
  ds_add_rtn_u32 v13, v12, v13
  s_waitcnt lgkmcnt(0)
  s_mov_b64 exec, -1
  v_readfirstlane_b32 s12, v13
  s_nop 0
  s_cmp_lg_u32 s12, 3
  s_cbranch_scc1 L_noflag1
  v_mov_b32 v12, s14
  v_mov_b32 v13, s8
  s_mov_b64 exec, 1
  buffer_store_dword v13, v12, s[44:47], 0 offen sc1
  s_mov_b64 exec, -1
L_noflag1:
L_attn:
  s_setprio 3
  s_and_b32 s12, s5, 1
  s_lshl_b32 s64, s4, 1
  s_add_u32 s64, s64, s12
  s_lshr_b32 s65, s5, 1
  s_lshl_b32 s66, s65, 2
  s_add_u32 s66, s66, s3
  s_mov_b32 s67, 0
  s_lshl_b32 s12, s64, 2
  s_add_u32 s12, s12, s3
  s_lshl_b32 s12, s12, 16
  s_add_u32 s12, s12, 3145728
  s_add_u32 s60, s44, s12
  s_addc_u32 s61, s45, 0
  s_mov_b32 s62, 65536
  s_mov_b32 s63, 0x00020000
  s_mul_i32 s12, s64, 28
  v_bfe_u32 v226, v1, 2, 2
  v_and_b32 v227, 1, v226
  v_mul_u32_u24 v227, 27, v227
  v_add_u32 v227, s12, v227
  v_lshrrev_b32 v226, 1, v226
  v_sub_u32 v228, 6, v226
  v_lshrrev_b32 v227, v228, v227
  v_sub_u32 v226, 1, v226
  v_mul_u32_u24 v226, 7, v226
  v_add_u32 v227, v227, v226
  v_lshlrev_b32 v227, 4, v227
  v_and_b32 v226, 3, v1
  v_add_u32 v227, v227, v226
  s_lshl_b32 s13, s3, 2
  v_add_u32 v224, s13, v227
  v_and_b32 v226, 1, v1
  v_mul_u32_u24 v226, 27, v226
  v_add_u32 v226, s12, v226
  v_lshrrev_b32 v226, 6, v226
  v_lshlrev_b32 v226, 4, v226
  s_mov_b64 exec, s[52:53]
  v_add_u32 v224, s65, v226
  s_mov_b64 exec, -1
  v_lshlrev_b32 v224, 7, v224
  v_add_u32 v224, 65536, v224
  s_lshl_b32 s13, s65, 2
  s_lshl_b32 s12, s64, 6
  s_add_u32 s12, s12, s13
  s_lshl_b32 s12, s12, 11
  s_add_u32 s12, s12, 1048576
  v_add_u32 v221, s12, v4
  v_cmp_eq_u32 vcc, 28, v2
  v_mov_b32 v226, 0x3F803F80
  s_nop 0
  v_cndmask_b32 v226, 0, v226, vcc
  v_mov_b32 v227, v226
  v_mov_b64 v[136:137], 0
  v_mov_b64 v[138:139], 0
  v_mov_b64 v[184:185], v[226:227]
  v_mov_b64 v[186:187], v[226:227]
  v_mov_b64 v[188:189], v[226:227]
  v_mov_b64 v[190:191], v[226:227]
  v_mov_b64 v[192:193], v[226:227]
  v_mov_b64 v[194:195], v[226:227]
  v_mov_b64 v[196:197], v[226:227]
  v_mov_b64 v[198:199], v[226:227]
  v_mov_b64 v[200:201], v[226:227]
  v_mov_b64 v[202:203], v[226:227]
  v_mov_b64 v[204:205], v[226:227]
  v_mov_b64 v[206:207], v[226:227]
  v_mov_b64 v[208:209], v[226:227]
  v_mov_b64 v[210:211], v[226:227]
  v_mov_b64 v[212:213], v[226:227]
  v_mov_b64 v[214:215], v[226:227]
  v_mfma_f32_32x32x16_bf16 v[40:55], v[136:139], v[136:139], 0
  v_mfma_f32_32x32x16_bf16 v[56:71], v[136:139], v[136:139], 0
  v_mfma_f32_32x32x16_bf16 v[72:87], v[136:139], v[136:139], 0
  v_mfma_f32_32x32x16_bf16 v[88:103], v[136:139], v[136:139], 0
  s_lshl_b32 s12, s66, 8
  s_add_u32 s12, s12, 393216
  v_lshl_add_u32 v246, v2, 3, s12
  s_lshr_b32 s12, s65, 2
  s_lshl_b32 s72, 0x00110011, s12
  s_mov_b32 s73, -1
  s_mov_b32 s12, 100000
  buffer_load_dword v240, v224, s[44:47], 0 offen sc1
  s_sleep 6
L_poll_1:
  buffer_load_dword v241, v224, s[44:47], 0 offen sc1
  s_waitcnt vmcnt(1)
  v_xor_b32 v240, s8, v240
  v_cmp_ne_u32 vcc, 0, v240
  s_nop 0
  s_cbranch_vccz L_polld_2
  s_sleep 6
  buffer_load_dword v240, v224, s[44:47], 0 offen sc1
  s_waitcnt vmcnt(1)
  v_xor_b32 v241, s8, v241
  v_cmp_ne_u32 vcc, 0, v241
  s_nop 0
  s_cbranch_vccz L_polld_2
  s_sleep 6
  s_sub_u32 s12, s12, 1
  s_cmp_lg_u32 s12, 0
  s_cbranch_scc1 L_poll_1
L_polld_2:
  v_mov_b32 v226, 159788
  v_mov_b32 v227, 1
  s_mov_b64 exec, 1
  ds_add_u32 v226, v227
  s_mov_b64 exec, -1
  s_mov_b32 s62, 65536
  s_lshl_b32 s68, s65, 12
  buffer_load_dwordx4 v[152:155], v4, s[60:63], s68 offen offset:0 sc1
  buffer_load_dwordx4 v[156:159], v4, s[60:63], s68 offen offset:1024 sc1
  s_add_u32 s13, s3, 0
  s_and_b32 s13, s13, 3
  s_lshl_b32 s13, s13, 11
  buffer_load_dwordx4 v[8:11], v221, s[44:47], s13 offen offset:0 sc1
  buffer_load_dwordx4 v[12:15], v221, s[44:47], s13 offen offset:1024 sc1
  s_add_u32 s13, s3, 1
  s_and_b32 s13, s13, 3
  s_lshl_b32 s13, s13, 11
  buffer_load_dwordx4 v[16:19], v221, s[44:47], s13 offen offset:0 sc1
  buffer_load_dwordx4 v[20:23], v221, s[44:47], s13 offen offset:1024 sc1
  s_add_u32 s13, s3, 2
  s_and_b32 s13, s13, 3
  s_lshl_b32 s13, s13, 11
  buffer_load_dwordx4 v[24:27], v221, s[44:47], s13 offen offset:0 sc1
  buffer_load_dwordx4 v[28:31], v221, s[44:47], s13 offen offset:1024 sc1
  s_add_u32 s13, s3, 3
  s_and_b32 s13, s13, 3
  s_lshl_b32 s13, s13, 11
  buffer_load_dwordx4 v[32:35], v221, s[44:47], s13 offen offset:0 sc1
  buffer_load_dwordx4 v[36:39], v221, s[44:47], s13 offen offset:1024 sc1
  buffer_load_dwordx2 v[222:223], v246, s[44:47], 0 offen sc1
  s_mov_b64 exec, s[56:57]
  buffer_load_dwordx4 v[184:187], v4, s[60:63], s68 offen offset:2048 sc1
  buffer_load_dwordx4 v[188:191], v4, s[60:63], s68 offen offset:3072 sc1
  s_mov_b64 exec, -1
  s_add_u32 s68, s68, 4096
  s_and_b32 s68, s68, 0xffff
  buffer_load_dwordx4 v[160:163], v4, s[60:63], s68 offen offset:0 sc1
  buffer_load_dwordx4 v[164:167], v4, s[60:63], s68 offen offset:1024 sc1
  s_mov_b64 exec, s[56:57]
  buffer_load_dwordx4 v[192:195], v4, s[60:63], s68 offen offset:2048 sc1
  buffer_load_dwordx4 v[196:199], v4, s[60:63], s68 offen offset:3072 sc1
  s_mov_b64 exec, -1
  s_add_u32 s68, s68, 4096
  s_and_b32 s68, s68, 0xffff
  buffer_load_dwordx4 v[168:171], v4, s[60:63], s68 offen offset:0 sc1
  buffer_load_dwordx4 v[172:175], v4, s[60:63], s68 offen offset:1024 sc1
  s_mov_b64 exec, s[56:57]
  buffer_load_dwordx4 v[200:203], v4, s[60:63], s68 offen offset:2048 sc1
  buffer_load_dwordx4 v[204:207], v4, s[60:63], s68 offen offset:3072 sc1
  s_mov_b64 exec, -1
  s_add_u32 s68, s68, 4096
  s_and_b32 s68, s68, 0xffff
  v_mov_b32 v216, 0xff800000
  v_mov_b32 v217, 0xff800000
  v_mov_b32 v218, 0xff800000
  v_mov_b32 v219, 0xff800000
  s_waitcnt vmcnt(10)
  v_mfma_f32_32x32x16_bf16 v[104:119], v[152:155], v[8:11], 0
  v_mfma_f32_32x32x16_bf16 v[104:119], v[156:159], v[12:15], v[104:119]
  v_mfma_f32_32x32x16_bf16 v[120:135], v[152:155], v[16:19], 0
  v_mfma_f32_32x32x16_bf16 v[120:135], v[156:159], v[20:23], v[120:135]
  s_nop 9
  v_max3_f32 v216, v216, v104, v105
  v_max3_f32 v216, v216, v106, v107
  v_max3_f32 v216, v216, v108, v109
  v_max3_f32 v216, v216, v110, v111
  v_max3_f32 v216, v216, v112, v113
  v_max3_f32 v216, v216, v114, v115
  v_max3_f32 v216, v216, v116, v117
  v_max3_f32 v216, v216, v118, v119
  v_mfma_f32_32x32x16_bf16 v[104:119], v[152:155], v[24:27], 0
  v_mfma_f32_32x32x16_bf16 v[104:119], v[156:159], v[28:31], v[104:119]
  v_max3_f32 v217, v217, v120, v121
  v_max3_f32 v217, v217, v122, v123
  v_max3_f32 v217, v217, v124, v125
  v_max3_f32 v217, v217, v126, v127
  v_max3_f32 v217, v217, v128, v129
  v_max3_f32 v217, v217, v130, v131
  v_max3_f32 v217, v217, v132, v133
  v_max3_f32 v217, v217, v134, v135
  v_mfma_f32_32x32x16_bf16 v[120:135], v[152:155], v[32:35], 0
  v_mfma_f32_32x32x16_bf16 v[120:135], v[156:159], v[36:39], v[120:135]
  s_nop 1
  v_max3_f32 v218, v218, v104, v105
  v_max3_f32 v218, v218, v106, v107
  v_max3_f32 v218, v218, v108, v109
  v_max3_f32 v218, v218, v110, v111
  v_max3_f32 v218, v218, v112, v113
  v_max3_f32 v218, v218, v114, v115
  v_max3_f32 v218, v218, v116, v117
  v_max3_f32 v218, v218, v118, v119
  s_nop 1
  v_max3_f32 v219, v219, v120, v121
  v_max3_f32 v219, v219, v122, v123
  v_max3_f32 v219, v219, v124, v125
  v_max3_f32 v219, v219, v126, v127
  v_max3_f32 v219, v219, v128, v129
  v_max3_f32 v219, v219, v130, v131
  v_max3_f32 v219, v219, v132, v133
  v_max3_f32 v219, v219, v134, v135
L_maxdone:
  v_mov_b32 v224, v216
  v_mov_b32 v225, v216
  v_mov_b32 v228, v217
  v_mov_b32 v229, v217
  v_mov_b32 v232, v218
  v_mov_b32 v233, v218
  v_mov_b32 v236, v219
  v_mov_b32 v237, v219
  v_permlane32_swap_b32 v224, v225
  v_permlane32_swap_b32 v228, v229
  v_permlane32_swap_b32 v232, v233
  v_permlane32_swap_b32 v236, v237
  v_max_f32 v216, v224, v225
  v_add_f32 v216, 0x41f00000, v216
  v_sub_f32 v224, 0, v216
  v_cvt_pk_bf16_f32 v225, v224, v224
  v_lshlrev_b32 v225, 16, v225
  v_sub_f32 v225, v224, v225
  v_cvt_pk_bf16_f32 v226, v224, v225
  v_and_b32 v227, 0xffff0000, v226
  v_sub_f32 v225, v225, v227
  v_cvt_pk_bf16_f32 v227, v225, 0
  v_max_f32 v217, v228, v229
  v_add_f32 v217, 0x41f00000, v217
  v_sub_f32 v228, 0, v217
  v_cvt_pk_bf16_f32 v229, v228, v228
  v_lshlrev_b32 v229, 16, v229
  v_sub_f32 v229, v228, v229
  v_cvt_pk_bf16_f32 v230, v228, v229
  v_and_b32 v231, 0xffff0000, v230
  v_sub_f32 v229, v229, v231
  v_cvt_pk_bf16_f32 v231, v229, 0
  v_max_f32 v218, v232, v233
  v_add_f32 v218, 0x41f00000, v218
  v_sub_f32 v232, 0, v218
  v_cvt_pk_bf16_f32 v233, v232, v232
  v_lshlrev_b32 v233, 16, v233
  v_sub_f32 v233, v232, v233
  v_cvt_pk_bf16_f32 v234, v232, v233
  v_and_b32 v235, 0xffff0000, v234
  v_sub_f32 v233, v233, v235
  v_cvt_pk_bf16_f32 v235, v233, 0
  v_max_f32 v219, v236, v237
  v_add_f32 v219, 0x41f00000, v219
  v_sub_f32 v236, 0, v219
  v_cvt_pk_bf16_f32 v237, v236, v236
  v_lshlrev_b32 v237, 16, v237
  v_sub_f32 v237, v236, v237
  v_cvt_pk_bf16_f32 v238, v236, v237
  v_and_b32 v239, 0xffff0000, v238
  v_sub_f32 v237, v237, v239
  v_cvt_pk_bf16_f32 v239, v237, 0
  s_bitcmp1_b32 s64, 0
  s_cbranch_scc1 L_odd_3
  s_mov_b64 exec, s[52:53]
  v_mov_b32 v14, v226
  v_mov_b32 v15, v227
  v_mov_b32 v22, v230
  v_mov_b32 v23, v231
  v_mov_b32 v30, v234
  v_mov_b32 v31, v235
  v_mov_b32 v38, v238
  v_mov_b32 v39, v239
  s_branch L_pe_4
L_odd_3:
  s_mov_b64 exec, s[54:55]
  v_mov_b32 v8, v226
  v_mov_b32 v9, v227
  v_mov_b32 v16, v230
  v_mov_b32 v17, v231
  v_mov_b32 v24, v234
  v_mov_b32 v25, v235
  v_mov_b32 v32, v238
  v_mov_b32 v33, v239
L_pe_4:
  s_mov_b64 exec, -1
  v_mov_b32 v132, 0
  v_mov_b32 v133, 0
  v_mov_b32 v134, 0
  v_mov_b32 v135, 0
  v_mov_b32 v148, 0
  v_mov_b32 v149, 0
  v_mfma_f32_32x32x16_bf16 v[104:119], v[152:155], v[8:11], 0
  v_mfma_f32_32x32x16_bf16 v[104:119], v[156:159], v[12:15], v[104:119]
  s_mov_b32 s70, 4
  s_setprio 1
  s_waitcnt vmcnt(8)
  s_nop 7
  s_nop 3
.p2align 6
L_main:
  v_exp_f32 v104, v104
  v_cvt_pk_bf16_f32 v150, v132, v133
  v_exp_f32 v105, v105
  v_cvt_pk_bf16_f32 v151, v134, v135
  v_exp_f32 v106, v106
  v_exp_f32 v107, v107
  v_mfma_f32_32x32x16_bf16 v[120:135], v[152:155], v[16:19], 0
  v_exp_f32 v108, v108
  v_cvt_pk_bf16_f32 v136, v104, v105
  v_exp_f32 v109, v109
  v_cvt_pk_bf16_f32 v137, v106, v107
  v_exp_f32 v110, v110
  v_exp_f32 v111, v111
  v_mfma_f32_32x32x16_bf16 v[120:135], v[156:159], v[20:23], v[120:135]
  v_exp_f32 v112, v112
  v_cvt_pk_bf16_f32 v138, v108, v109
  v_exp_f32 v113, v113
  v_cvt_pk_bf16_f32 v139, v110, v111
  v_exp_f32 v114, v114
  v_exp_f32 v115, v115
  v_mfma_f32_32x32x16_bf16 v[88:103], v[212:215], v[148:151], v[88:103]
  v_exp_f32 v116, v116
  v_cvt_pk_bf16_f32 v140, v112, v113
  v_exp_f32 v117, v117
  v_cvt_pk_bf16_f32 v141, v114, v115
  v_exp_f32 v118, v118
  v_exp_f32 v119, v119
  v_mfma_f32_32x32x16_bf16 v[40:55], v[184:187], v[136:139], v[40:55]
  v_exp_f32 v120, v120
  v_cvt_pk_bf16_f32 v142, v116, v117
  v_exp_f32 v121, v121
  v_cvt_pk_bf16_f32 v143, v118, v119
  v_exp_f32 v122, v122
  v_exp_f32 v123, v123
  v_mfma_f32_32x32x16_bf16 v[104:119], v[152:155], v[24:27], 0
  v_exp_f32 v124, v124
  v_cvt_pk_bf16_f32 v144, v120, v121
  v_exp_f32 v125, v125
  v_cvt_pk_bf16_f32 v145, v122, v123
  v_exp_f32 v126, v126
  v_exp_f32 v127, v127
  v_mfma_f32_32x32x16_bf16 v[104:119], v[156:159], v[28:31], v[104:119]
  v_exp_f32 v128, v128
  v_cvt_pk_bf16_f32 v146, v124, v125
  v_exp_f32 v129, v129
  v_cvt_pk_bf16_f32 v147, v126, v127
  v_exp_f32 v130, v130
  v_exp_f32 v131, v131
  v_mfma_f32_32x32x16_bf16 v[40:55], v[188:191], v[140:143], v[40:55]
  v_exp_f32 v132, v132
  v_cvt_pk_bf16_f32 v148, v128, v129
  v_exp_f32 v133, v133
  v_cvt_pk_bf16_f32 v149, v130, v131
  v_exp_f32 v134, v134
  v_exp_f32 v135, v135
  v_mfma_f32_32x32x16_bf16 v[56:71], v[184:187], v[144:147], v[56:71]
  buffer_load_dwordx4 v[176:179], v4, s[60:63], s68 offen offset:0 sc1
  buffer_load_dwordx4 v[180:183], v4, s[60:63], s68 offen offset:1024 sc1
  s_mov_b64 exec, s[56:57]
  buffer_load_dwordx4 v[208:211], v4, s[60:63], s68 offen offset:2048 sc1
  buffer_load_dwordx4 v[212:215], v4, s[60:63], s68 offen offset:3072 sc1
  s_mov_b64 exec, -1
  s_add_u32 s68, s68, 4096
  s_and_b32 s68, s68, 0xffff
  s_cmp_eq_u32 s70, 1
  s_cselect_b32 s62, 0, 65536
  v_exp_f32 v104, v104
  v_cvt_pk_bf16_f32 v150, v132, v133
  v_exp_f32 v105, v105
  v_cvt_pk_bf16_f32 v151, v134, v135
  v_exp_f32 v106, v106
  v_exp_f32 v107, v107
  v_mfma_f32_32x32x16_bf16 v[120:135], v[152:155], v[32:35], 0
  v_exp_f32 v108, v108
  v_cvt_pk_bf16_f32 v136, v104, v105
  v_exp_f32 v109, v109
  v_cvt_pk_bf16_f32 v137, v106, v107
  v_exp_f32 v110, v110
  v_exp_f32 v111, v111
  v_mfma_f32_32x32x16_bf16 v[120:135], v[156:159], v[36:39], v[120:135]
  v_exp_f32 v112, v112
  v_cvt_pk_bf16_f32 v138, v108, v109
  v_exp_f32 v113, v113
  v_cvt_pk_bf16_f32 v139, v110, v111
  v_exp_f32 v114, v114
  v_exp_f32 v115, v115
  v_mfma_f32_32x32x16_bf16 v[56:71], v[188:191], v[148:151], v[56:71]
  v_exp_f32 v116, v116
  v_cvt_pk_bf16_f32 v140, v112, v113
  v_exp_f32 v117, v117
  v_cvt_pk_bf16_f32 v141, v114, v115
  v_exp_f32 v118, v118
  v_exp_f32 v119, v119
  v_mfma_f32_32x32x16_bf16 v[72:87], v[184:187], v[136:139], v[72:87]
  v_exp_f32 v120, v120
  v_cvt_pk_bf16_f32 v142, v116, v117
  v_exp_f32 v121, v121
  v_cvt_pk_bf16_f32 v143, v118, v119
  v_exp_f32 v122, v122
  v_exp_f32 v123, v123
  s_waitcnt vmcnt(8)
  v_mfma_f32_32x32x16_bf16 v[104:119], v[160:163], v[8:11], 0
  v_exp_f32 v124, v124
  v_cvt_pk_bf16_f32 v144, v120, v121
  v_exp_f32 v125, v125
  v_cvt_pk_bf16_f32 v145, v122, v123
  v_exp_f32 v126, v126
  v_exp_f32 v127, v127
  v_mfma_f32_32x32x16_bf16 v[104:119], v[164:167], v[12:15], v[104:119]
  v_exp_f32 v128, v128
  v_cvt_pk_bf16_f32 v146, v124, v125
  v_exp_f32 v129, v129
  v_cvt_pk_bf16_f32 v147, v126, v127
  v_exp_f32 v130, v130
  v_exp_f32 v131, v131
  v_mfma_f32_32x32x16_bf16 v[72:87], v[188:191], v[140:143], v[72:87]
  v_exp_f32 v132, v132
  v_cvt_pk_bf16_f32 v148, v128, v129
  v_exp_f32 v133, v133
  v_cvt_pk_bf16_f32 v149, v130, v131
  v_exp_f32 v134, v134
  v_exp_f32 v135, v135
  v_mfma_f32_32x32x16_bf16 v[88:103], v[184:187], v[144:147], v[88:103]
  v_exp_f32 v104, v104
  v_cvt_pk_bf16_f32 v150, v132, v133
  v_exp_f32 v105, v105
  v_cvt_pk_bf16_f32 v151, v134, v135
  v_exp_f32 v106, v106
  v_exp_f32 v107, v107
  v_mfma_f32_32x32x16_bf16 v[120:135], v[160:163], v[16:19], 0
  v_exp_f32 v108, v108
  v_cvt_pk_bf16_f32 v136, v104, v105
  v_exp_f32 v109, v109
  v_cvt_pk_bf16_f32 v137, v106, v107
  v_exp_f32 v110, v110
  v_exp_f32 v111, v111
  v_mfma_f32_32x32x16_bf16 v[120:135], v[164:167], v[20:23], v[120:135]
  v_exp_f32 v112, v112
  v_cvt_pk_bf16_f32 v138, v108, v109
  v_exp_f32 v113, v113
  v_cvt_pk_bf16_f32 v139, v110, v111
  v_exp_f32 v114, v114
  v_exp_f32 v115, v115
  v_mfma_f32_32x32x16_bf16 v[88:103], v[188:191], v[148:151], v[88:103]
  v_exp_f32 v116, v116
  v_cvt_pk_bf16_f32 v140, v112, v113
  v_exp_f32 v117, v117
  v_cvt_pk_bf16_f32 v141, v114, v115
  v_exp_f32 v118, v118
  v_exp_f32 v119, v119
  v_mfma_f32_32x32x16_bf16 v[40:55], v[192:195], v[136:139], v[40:55]
  v_exp_f32 v120, v120
  v_cvt_pk_bf16_f32 v142, v116, v117
  v_exp_f32 v121, v121
  v_cvt_pk_bf16_f32 v143, v118, v119
  v_exp_f32 v122, v122
  v_exp_f32 v123, v123
  v_mfma_f32_32x32x16_bf16 v[104:119], v[160:163], v[24:27], 0
  v_exp_f32 v124, v124
  v_cvt_pk_bf16_f32 v144, v120, v121
  v_exp_f32 v125, v125
  v_cvt_pk_bf16_f32 v145, v122, v123
  v_exp_f32 v126, v126
  v_exp_f32 v127, v127
  v_mfma_f32_32x32x16_bf16 v[104:119], v[164:167], v[28:31], v[104:119]
  v_exp_f32 v128, v128
  v_cvt_pk_bf16_f32 v146, v124, v125
  v_exp_f32 v129, v129
  v_cvt_pk_bf16_f32 v147, v126, v127
  v_exp_f32 v130, v130
  v_exp_f32 v131, v131
  v_mfma_f32_32x32x16_bf16 v[40:55], v[196:199], v[140:143], v[40:55]
  v_exp_f32 v132, v132
  v_cvt_pk_bf16_f32 v148, v128, v129
  v_exp_f32 v133, v133
  v_cvt_pk_bf16_f32 v149, v130, v131
  v_exp_f32 v134, v134
  v_exp_f32 v135, v135
  v_mfma_f32_32x32x16_bf16 v[56:71], v[192:195], v[144:147], v[56:71]
  buffer_load_dwordx4 v[152:155], v4, s[60:63], s68 offen offset:0 sc1
  buffer_load_dwordx4 v[156:159], v4, s[60:63], s68 offen offset:1024 sc1
  s_mov_b64 exec, s[56:57]
  buffer_load_dwordx4 v[184:187], v4, s[60:63], s68 offen offset:2048 sc1
  buffer_load_dwordx4 v[188:191], v4, s[60:63], s68 offen offset:3072 sc1
  s_mov_b64 exec, -1
  s_add_u32 s68, s68, 4096
  s_and_b32 s68, s68, 0xffff
  v_exp_f32 v104, v104
  v_cvt_pk_bf16_f32 v150, v132, v133
  v_exp_f32 v105, v105
  v_cvt_pk_bf16_f32 v151, v134, v135
  v_exp_f32 v106, v106
  v_exp_f32 v107, v107
  v_mfma_f32_32x32x16_bf16 v[120:135], v[160:163], v[32:35], 0
  v_exp_f32 v108, v108
  v_cvt_pk_bf16_f32 v136, v104, v105
  v_exp_f32 v109, v109
  v_cvt_pk_bf16_f32 v137, v106, v107
  v_exp_f32 v110, v110
  v_exp_f32 v111, v111
  v_mfma_f32_32x32x16_bf16 v[120:135], v[164:167], v[36:39], v[120:135]
  v_exp_f32 v112, v112
  v_cvt_pk_bf16_f32 v138, v108, v109
  v_exp_f32 v113, v113
  v_cvt_pk_bf16_f32 v139, v110, v111
  v_exp_f32 v114, v114
  v_exp_f32 v115, v115
  v_mfma_f32_32x32x16_bf16 v[56:71], v[196:199], v[148:151], v[56:71]
  v_exp_f32 v116, v116
  v_cvt_pk_bf16_f32 v140, v112, v113
  v_exp_f32 v117, v117
  v_cvt_pk_bf16_f32 v141, v114, v115
  v_exp_f32 v118, v118
  v_exp_f32 v119, v119
  v_mfma_f32_32x32x16_bf16 v[72:87], v[192:195], v[136:139], v[72:87]
  v_exp_f32 v120, v120
  v_cvt_pk_bf16_f32 v142, v116, v117
  v_exp_f32 v121, v121
  v_cvt_pk_bf16_f32 v143, v118, v119
  v_exp_f32 v122, v122
  v_exp_f32 v123, v123
  s_waitcnt vmcnt(8)
  v_mfma_f32_32x32x16_bf16 v[104:119], v[168:171], v[8:11], 0
  v_exp_f32 v124, v124
  v_cvt_pk_bf16_f32 v144, v120, v121
  v_exp_f32 v125, v125
  v_cvt_pk_bf16_f32 v145, v122, v123
  v_exp_f32 v126, v126
  v_exp_f32 v127, v127
  v_mfma_f32_32x32x16_bf16 v[104:119], v[172:175], v[12:15], v[104:119]
  v_exp_f32 v128, v128
  v_cvt_pk_bf16_f32 v146, v124, v125
  v_exp_f32 v129, v129
  v_cvt_pk_bf16_f32 v147, v126, v127
  v_exp_f32 v130, v130
  v_exp_f32 v131, v131
  v_mfma_f32_32x32x16_bf16 v[72:87], v[196:199], v[140:143], v[72:87]
  v_exp_f32 v132, v132
  v_cvt_pk_bf16_f32 v148, v128, v129
  v_exp_f32 v133, v133
  v_cvt_pk_bf16_f32 v149, v130, v131
  v_exp_f32 v134, v134
  v_exp_f32 v135, v135
  v_mfma_f32_32x32x16_bf16 v[88:103], v[192:195], v[144:147], v[88:103]
  v_exp_f32 v104, v104
  v_cvt_pk_bf16_f32 v150, v132, v133
  v_exp_f32 v105, v105
  v_cvt_pk_bf16_f32 v151, v134, v135
  v_exp_f32 v106, v106
  v_exp_f32 v107, v107
  v_mfma_f32_32x32x16_bf16 v[120:135], v[168:171], v[16:19], 0
  v_exp_f32 v108, v108
  v_cvt_pk_bf16_f32 v136, v104, v105
  v_exp_f32 v109, v109
  v_cvt_pk_bf16_f32 v137, v106, v107
  v_exp_f32 v110, v110
  v_exp_f32 v111, v111
  v_mfma_f32_32x32x16_bf16 v[120:135], v[172:175], v[20:23], v[120:135]
  v_exp_f32 v112, v112
  v_cvt_pk_bf16_f32 v138, v108, v109
  v_exp_f32 v113, v113
  v_cvt_pk_bf16_f32 v139, v110, v111
  v_exp_f32 v114, v114
  v_exp_f32 v115, v115
  v_mfma_f32_32x32x16_bf16 v[88:103], v[196:199], v[148:151], v[88:103]
  v_exp_f32 v116, v116
  v_cvt_pk_bf16_f32 v140, v112, v113
  v_exp_f32 v117, v117
  v_cvt_pk_bf16_f32 v141, v114, v115
  v_exp_f32 v118, v118
  v_exp_f32 v119, v119
  v_mfma_f32_32x32x16_bf16 v[40:55], v[200:203], v[136:139], v[40:55]
  v_exp_f32 v120, v120
  v_cvt_pk_bf16_f32 v142, v116, v117
  v_exp_f32 v121, v121
  v_cvt_pk_bf16_f32 v143, v118, v119
  v_exp_f32 v122, v122
  v_exp_f32 v123, v123
  v_mfma_f32_32x32x16_bf16 v[104:119], v[168:171], v[24:27], 0
  v_exp_f32 v124, v124
  v_cvt_pk_bf16_f32 v144, v120, v121
  v_exp_f32 v125, v125
  v_cvt_pk_bf16_f32 v145, v122, v123
  v_exp_f32 v126, v126
  v_exp_f32 v127, v127
  v_mfma_f32_32x32x16_bf16 v[104:119], v[172:175], v[28:31], v[104:119]
  v_exp_f32 v128, v128
  v_cvt_pk_bf16_f32 v146, v124, v125
  v_exp_f32 v129, v129
  v_cvt_pk_bf16_f32 v147, v126, v127
  v_exp_f32 v130, v130
  v_exp_f32 v131, v131
  v_mfma_f32_32x32x16_bf16 v[40:55], v[204:207], v[140:143], v[40:55]
  v_exp_f32 v132, v132
  v_cvt_pk_bf16_f32 v148, v128, v129
  v_exp_f32 v133, v133
  v_cvt_pk_bf16_f32 v149, v130, v131
  v_exp_f32 v134, v134
  v_exp_f32 v135, v135
  v_mfma_f32_32x32x16_bf16 v[56:71], v[200:203], v[144:147], v[56:71]
  buffer_load_dwordx4 v[160:163], v4, s[60:63], s68 offen offset:0 sc1
  buffer_load_dwordx4 v[164:167], v4, s[60:63], s68 offen offset:1024 sc1
  s_mov_b64 exec, s[56:57]
  buffer_load_dwordx4 v[192:195], v4, s[60:63], s68 offen offset:2048 sc1
  buffer_load_dwordx4 v[196:199], v4, s[60:63], s68 offen offset:3072 sc1
  s_mov_b64 exec, -1
  s_add_u32 s68, s68, 4096
  s_and_b32 s68, s68, 0xffff
  v_exp_f32 v104, v104
  v_cvt_pk_bf16_f32 v150, v132, v133
  v_exp_f32 v105, v105
  v_cvt_pk_bf16_f32 v151, v134, v135
  v_exp_f32 v106, v106
  v_exp_f32 v107, v107
  v_mfma_f32_32x32x16_bf16 v[120:135], v[168:171], v[32:35], 0
  v_exp_f32 v108, v108
  v_cvt_pk_bf16_f32 v136, v104, v105
  v_exp_f32 v109, v109
  v_cvt_pk_bf16_f32 v137, v106, v107
  v_exp_f32 v110, v110
  v_exp_f32 v111, v111
  v_mfma_f32_32x32x16_bf16 v[120:135], v[172:175], v[36:39], v[120:135]
  v_exp_f32 v112, v112
  v_cvt_pk_bf16_f32 v138, v108, v109
  v_exp_f32 v113, v113
  v_cvt_pk_bf16_f32 v139, v110, v111
  v_exp_f32 v114, v114
  v_exp_f32 v115, v115
  v_mfma_f32_32x32x16_bf16 v[56:71], v[204:207], v[148:151], v[56:71]
  v_exp_f32 v116, v116
  v_cvt_pk_bf16_f32 v140, v112, v113
  v_exp_f32 v117, v117
  v_cvt_pk_bf16_f32 v141, v114, v115
  v_exp_f32 v118, v118
  v_exp_f32 v119, v119
  v_mfma_f32_32x32x16_bf16 v[72:87], v[200:203], v[136:139], v[72:87]
  v_exp_f32 v120, v120
  v_cvt_pk_bf16_f32 v142, v116, v117
  v_exp_f32 v121, v121
  v_cvt_pk_bf16_f32 v143, v118, v119
  v_exp_f32 v122, v122
  v_exp_f32 v123, v123
  s_waitcnt vmcnt(8)
  v_mfma_f32_32x32x16_bf16 v[104:119], v[176:179], v[8:11], 0
  v_exp_f32 v124, v124
  v_cvt_pk_bf16_f32 v144, v120, v121
  v_exp_f32 v125, v125
  v_cvt_pk_bf16_f32 v145, v122, v123
  v_exp_f32 v126, v126
  v_exp_f32 v127, v127
  v_mfma_f32_32x32x16_bf16 v[104:119], v[180:183], v[12:15], v[104:119]
  v_exp_f32 v128, v128
  v_cvt_pk_bf16_f32 v146, v124, v125
  v_exp_f32 v129, v129
  v_cvt_pk_bf16_f32 v147, v126, v127
  v_exp_f32 v130, v130
  v_exp_f32 v131, v131
  v_mfma_f32_32x32x16_bf16 v[72:87], v[204:207], v[140:143], v[72:87]
  v_exp_f32 v132, v132
  v_cvt_pk_bf16_f32 v148, v128, v129
  v_exp_f32 v133, v133
  v_cvt_pk_bf16_f32 v149, v130, v131
  v_exp_f32 v134, v134
  v_exp_f32 v135, v135
  v_mfma_f32_32x32x16_bf16 v[88:103], v[200:203], v[144:147], v[88:103]
  v_exp_f32 v104, v104
  v_cvt_pk_bf16_f32 v150, v132, v133
  v_exp_f32 v105, v105
  v_cvt_pk_bf16_f32 v151, v134, v135
  v_exp_f32 v106, v106
  v_exp_f32 v107, v107
  v_mfma_f32_32x32x16_bf16 v[120:135], v[176:179], v[16:19], 0
  v_exp_f32 v108, v108
  v_cvt_pk_bf16_f32 v136, v104, v105
  v_exp_f32 v109, v109
  v_cvt_pk_bf16_f32 v137, v106, v107
  v_exp_f32 v110, v110
  v_exp_f32 v111, v111
  v_mfma_f32_32x32x16_bf16 v[120:135], v[180:183], v[20:23], v[120:135]
  v_exp_f32 v112, v112
  v_cvt_pk_bf16_f32 v138, v108, v109
  v_exp_f32 v113, v113
  v_cvt_pk_bf16_f32 v139, v110, v111
  v_exp_f32 v114, v114
  v_exp_f32 v115, v115
  v_mfma_f32_32x32x16_bf16 v[88:103], v[204:207], v[148:151], v[88:103]
  v_exp_f32 v116, v116
  v_cvt_pk_bf16_f32 v140, v112, v113
  v_exp_f32 v117, v117
  v_cvt_pk_bf16_f32 v141, v114, v115
  v_exp_f32 v118, v118
  v_exp_f32 v119, v119
  v_mfma_f32_32x32x16_bf16 v[40:55], v[208:211], v[136:139], v[40:55]
  v_exp_f32 v120, v120
  v_cvt_pk_bf16_f32 v142, v116, v117
  v_exp_f32 v121, v121
  v_cvt_pk_bf16_f32 v143, v118, v119
  v_exp_f32 v122, v122
  v_exp_f32 v123, v123
  v_mfma_f32_32x32x16_bf16 v[104:119], v[176:179], v[24:27], 0
  v_exp_f32 v124, v124
  v_cvt_pk_bf16_f32 v144, v120, v121
  v_exp_f32 v125, v125
  v_cvt_pk_bf16_f32 v145, v122, v123
  v_exp_f32 v126, v126
  v_exp_f32 v127, v127
  v_mfma_f32_32x32x16_bf16 v[104:119], v[180:183], v[28:31], v[104:119]
  v_exp_f32 v128, v128
  v_cvt_pk_bf16_f32 v146, v124, v125
  v_exp_f32 v129, v129
  v_cvt_pk_bf16_f32 v147, v126, v127
  v_exp_f32 v130, v130
  v_exp_f32 v131, v131
  v_mfma_f32_32x32x16_bf16 v[40:55], v[212:215], v[140:143], v[40:55]
  v_exp_f32 v132, v132
  v_cvt_pk_bf16_f32 v148, v128, v129
  v_exp_f32 v133, v133
  v_cvt_pk_bf16_f32 v149, v130, v131
  v_exp_f32 v134, v134
  v_exp_f32 v135, v135
  v_mfma_f32_32x32x16_bf16 v[56:71], v[208:211], v[144:147], v[56:71]
  buffer_load_dwordx4 v[168:171], v4, s[60:63], s68 offen offset:0 sc1
  buffer_load_dwordx4 v[172:175], v4, s[60:63], s68 offen offset:1024 sc1
  s_mov_b64 exec, s[56:57]
  buffer_load_dwordx4 v[200:203], v4, s[60:63], s68 offen offset:2048 sc1
  buffer_load_dwordx4 v[204:207], v4, s[60:63], s68 offen offset:3072 sc1
  s_mov_b64 exec, -1
  s_add_u32 s68, s68, 4096
  s_and_b32 s68, s68, 0xffff
  v_exp_f32 v104, v104
  v_cvt_pk_bf16_f32 v150, v132, v133
  v_exp_f32 v105, v105
  v_cvt_pk_bf16_f32 v151, v134, v135
  v_exp_f32 v106, v106
  v_exp_f32 v107, v107
  v_mfma_f32_32x32x16_bf16 v[120:135], v[176:179], v[32:35], 0
  v_exp_f32 v108, v108
  v_cvt_pk_bf16_f32 v136, v104, v105
  v_exp_f32 v109, v109
  v_cvt_pk_bf16_f32 v137, v106, v107
  v_exp_f32 v110, v110
  v_exp_f32 v111, v111
  v_mfma_f32_32x32x16_bf16 v[120:135], v[180:183], v[36:39], v[120:135]
  v_exp_f32 v112, v112
  v_cvt_pk_bf16_f32 v138, v108, v109
  v_exp_f32 v113, v113
  v_cvt_pk_bf16_f32 v139, v110, v111
  v_exp_f32 v114, v114
  v_exp_f32 v115, v115
  v_mfma_f32_32x32x16_bf16 v[56:71], v[212:215], v[148:151], v[56:71]
  v_exp_f32 v116, v116
  v_cvt_pk_bf16_f32 v140, v112, v113
  v_exp_f32 v117, v117
  v_cvt_pk_bf16_f32 v141, v114, v115
  v_exp_f32 v118, v118
  v_exp_f32 v119, v119
  v_mfma_f32_32x32x16_bf16 v[72:87], v[208:211], v[136:139], v[72:87]
  v_exp_f32 v120, v120
  v_cvt_pk_bf16_f32 v142, v116, v117
  v_exp_f32 v121, v121
  v_cvt_pk_bf16_f32 v143, v118, v119
  v_exp_f32 v122, v122
  v_exp_f32 v123, v123
  s_waitcnt vmcnt(8)
  v_mfma_f32_32x32x16_bf16 v[104:119], v[152:155], v[8:11], 0
  v_exp_f32 v124, v124
  v_cvt_pk_bf16_f32 v144, v120, v121
  v_exp_f32 v125, v125
  v_cvt_pk_bf16_f32 v145, v122, v123
  v_exp_f32 v126, v126
  v_exp_f32 v127, v127
  v_mfma_f32_32x32x16_bf16 v[104:119], v[156:159], v[12:15], v[104:119]
  v_exp_f32 v128, v128
  v_cvt_pk_bf16_f32 v146, v124, v125
  v_exp_f32 v129, v129
  v_cvt_pk_bf16_f32 v147, v126, v127
  v_exp_f32 v130, v130
  v_exp_f32 v131, v131
  v_mfma_f32_32x32x16_bf16 v[72:87], v[212:215], v[140:143], v[72:87]
  v_exp_f32 v132, v132
  v_cvt_pk_bf16_f32 v148, v128, v129
  v_exp_f32 v133, v133
  v_cvt_pk_bf16_f32 v149, v130, v131
  v_exp_f32 v134, v134
  v_exp_f32 v135, v135
  v_mfma_f32_32x32x16_bf16 v[88:103], v[208:211], v[144:147], v[88:103]
  s_sub_u32 s70, s70, 1
  s_cmp_lg_u32 s70, 0
  s_cbranch_scc1 L_main
  v_cvt_pk_bf16_f32 v150, v132, v133
  v_cvt_pk_bf16_f32 v151, v134, v135
  s_nop 1
  v_mfma_f32_32x32x16_bf16 v[88:103], v[212:215], v[148:151], v[88:103]
  s_mov_b32 s12, 1484783616
  v_add_f32 v225, v52, v68
  s_nop 9
  v_add_f32 v226, v84, v100
  v_add_f32 v225, v225, v226
  v_cmp_nle_f32 vcc, v225, s12
  s_nop 0
  s_and_b64 s[14:15], vcc, s[52:53]
  s_cbranch_scc0 L_attn_ok
  s_cmp_lg_u32 s67, 0
  s_cbranch_scc1 L_attn_ok
  s_mov_b32 s67, 1
  s_waitcnt vmcnt(0)
  v_mov_b32 v216, 0xff800000
  v_mov_b32 v217, 0xff800000
  v_mov_b32 v218, 0xff800000
  v_mov_b32 v219, 0xff800000
  v_mov_b32 v40, 0
  v_mov_b32 v41, 0
  v_mov_b32 v42, 0
  v_mov_b32 v43, 0
  v_mov_b32 v44, 0
  v_mov_b32 v45, 0
  v_mov_b32 v46, 0
  v_mov_b32 v47, 0
  v_mov_b32 v48, 0
  v_mov_b32 v49, 0
  v_mov_b32 v50, 0
  v_mov_b32 v51, 0
  v_mov_b32 v52, 0
  v_mov_b32 v53, 0
  v_mov_b32 v54, 0
  v_mov_b32 v55, 0
  v_mov_b32 v56, 0
  v_mov_b32 v57, 0
  v_mov_b32 v58, 0
  v_mov_b32 v59, 0
  v_mov_b32 v60, 0
  v_mov_b32 v61, 0
  v_mov_b32 v62, 0
  v_mov_b32 v63, 0
  v_mov_b32 v64, 0
  v_mov_b32 v65, 0
  v_mov_b32 v66, 0
  v_mov_b32 v67, 0
  v_mov_b32 v68, 0
  v_mov_b32 v69, 0
  v_mov_b32 v70, 0
  v_mov_b32 v71, 0
  v_mov_b32 v72, 0
  v_mov_b32 v73, 0
  v_mov_b32 v74, 0
  v_mov_b32 v75, 0
  v_mov_b32 v76, 0
  v_mov_b32 v77, 0
  v_mov_b32 v78, 0
  v_mov_b32 v79, 0
  v_mov_b32 v80, 0
  v_mov_b32 v81, 0
  v_mov_b32 v82, 0
  v_mov_b32 v83, 0
  v_mov_b32 v84, 0
  v_mov_b32 v85, 0
  v_mov_b32 v86, 0
  v_mov_b32 v87, 0
  v_mov_b32 v88, 0
  v_mov_b32 v89, 0
  v_mov_b32 v90, 0
  v_mov_b32 v91, 0
  v_mov_b32 v92, 0
  v_mov_b32 v93, 0
  v_mov_b32 v94, 0
  v_mov_b32 v95, 0
  v_mov_b32 v96, 0
  v_mov_b32 v97, 0
  v_mov_b32 v98, 0
  v_mov_b32 v99, 0
  v_mov_b32 v100, 0
  v_mov_b32 v101, 0
  v_mov_b32 v102, 0
  v_mov_b32 v103, 0
  s_bitcmp1_b32 s64, 0
  s_cbranch_scc1 L_odd_5
  s_mov_b64 exec, s[52:53]
  v_mov_b32 v14, 0
  v_mov_b32 v15, 0
  v_mov_b32 v22, 0
  v_mov_b32 v23, 0
  v_mov_b32 v30, 0
  v_mov_b32 v31, 0
  v_mov_b32 v38, 0
  v_mov_b32 v39, 0
  s_branch L_pe_6
L_odd_5:
  s_mov_b64 exec, s[54:55]
  v_mov_b32 v8, 0
  v_mov_b32 v9, 0
  v_mov_b32 v16, 0
  v_mov_b32 v17, 0
  v_mov_b32 v24, 0
  v_mov_b32 v25, 0
  v_mov_b32 v32, 0
  v_mov_b32 v33, 0
L_pe_6:
  s_mov_b64 exec, -1
  s_mov_b32 s71, 0
  s_mov_b32 s62, 65536
L_maxloop:
  buffer_load_dwordx4 v[152:155], v4, s[60:63], s71 offen offset:0 sc1
  buffer_load_dwordx4 v[156:159], v4, s[60:63], s71 offen offset:1024 sc1
  s_waitcnt vmcnt(0)
  v_mfma_f32_32x32x16_bf16 v[104:119], v[152:155], v[8:11], 0
  v_mfma_f32_32x32x16_bf16 v[104:119], v[156:159], v[12:15], v[104:119]
  v_mfma_f32_32x32x16_bf16 v[120:135], v[152:155], v[16:19], 0
  v_mfma_f32_32x32x16_bf16 v[120:135], v[156:159], v[20:23], v[120:135]
  s_nop 9
  v_max3_f32 v216, v216, v104, v105
  v_max3_f32 v216, v216, v106, v107
  v_max3_f32 v216, v216, v108, v109
  v_max3_f32 v216, v216, v110, v111
  v_max3_f32 v216, v216, v112, v113
  v_max3_f32 v216, v216, v114, v115
  v_max3_f32 v216, v216, v116, v117
  v_max3_f32 v216, v216, v118, v119
  v_mfma_f32_32x32x16_bf16 v[104:119], v[152:155], v[24:27], 0
  v_mfma_f32_32x32x16_bf16 v[104:119], v[156:159], v[28:31], v[104:119]
  v_max3_f32 v217, v217, v120, v121
  v_max3_f32 v217, v217, v122, v123
  v_max3_f32 v217, v217, v124, v125
  v_max3_f32 v217, v217, v126, v127
  v_max3_f32 v217, v217, v128, v129
  v_max3_f32 v217, v217, v130, v131
  v_max3_f32 v217, v217, v132, v133
  v_max3_f32 v217, v217, v134, v135
  v_mfma_f32_32x32x16_bf16 v[120:135], v[152:155], v[32:35], 0
  v_mfma_f32_32x32x16_bf16 v[120:135], v[156:159], v[36:39], v[120:135]
  s_nop 1
  v_max3_f32 v218, v218, v104, v105
  v_max3_f32 v218, v218, v106, v107
  v_max3_f32 v218, v218, v108, v109
  v_max3_f32 v218, v218, v110, v111
  v_max3_f32 v218, v218, v112, v113
  v_max3_f32 v218, v218, v114, v115
  v_max3_f32 v218, v218, v116, v117
  v_max3_f32 v218, v218, v118, v119
  s_nop 1
  v_max3_f32 v219, v219, v120, v121
  v_max3_f32 v219, v219, v122, v123
  v_max3_f32 v219, v219, v124, v125
  v_max3_f32 v219, v219, v126, v127
  v_max3_f32 v219, v219, v128, v129
  v_max3_f32 v219, v219, v130, v131
  v_max3_f32 v219, v219, v132, v133
  v_max3_f32 v219, v219, v134, v135
  s_add_u32 s71, s71, 4096
  s_cmp_lt_u32 s71, 65536
  s_cbranch_scc1 L_maxloop
  s_mov_b32 s62, 65536
  s_lshl_b32 s68, s65, 12
  buffer_load_dwordx4 v[152:155], v4, s[60:63], s68 offen offset:0 sc1
  buffer_load_dwordx4 v[156:159], v4, s[60:63], s68 offen offset:1024 sc1
  s_mov_b64 exec, s[56:57]
  buffer_load_dwordx4 v[184:187], v4, s[60:63], s68 offen offset:2048 sc1
  buffer_load_dwordx4 v[188:191], v4, s[60:63], s68 offen offset:3072 sc1
  s_mov_b64 exec, -1
  s_add_u32 s68, s68, 4096
  s_and_b32 s68, s68, 0xffff
  buffer_load_dwordx4 v[160:163], v4, s[60:63], s68 offen offset:0 sc1
  buffer_load_dwordx4 v[164:167], v4, s[60:63], s68 offen offset:1024 sc1
  s_mov_b64 exec, s[56:57]
  buffer_load_dwordx4 v[192:195], v4, s[60:63], s68 offen offset:2048 sc1
  buffer_load_dwordx4 v[196:199], v4, s[60:63], s68 offen offset:3072 sc1
  s_mov_b64 exec, -1
  s_add_u32 s68, s68, 4096
  s_and_b32 s68, s68, 0xffff
  buffer_load_dwordx4 v[168:171], v4, s[60:63], s68 offen offset:0 sc1
  buffer_load_dwordx4 v[172:175], v4, s[60:63], s68 offen offset:1024 sc1
  s_mov_b64 exec, s[56:57]
  buffer_load_dwordx4 v[200:203], v4, s[60:63], s68 offen offset:2048 sc1
  buffer_load_dwordx4 v[204:207], v4, s[60:63], s68 offen offset:3072 sc1
  s_mov_b64 exec, -1
  s_add_u32 s68, s68, 4096
  s_and_b32 s68, s68, 0xffff
  s_waitcnt vmcnt(10)
  s_branch L_maxdone
L_attn_ok:
  s_setprio 3
  v_mov_b32 v226, 159792
  v_mov_b32 v227, 1
  s_mov_b64 exec, 1
  ds_add_u32 v226, v227
  s_mov_b64 exec, -1
  v_cmp_ne_u32 vcc, s8, v223
  s_nop 0
  s_cbranch_vccz L_gate_ok
  s_lshl_b32 s12, s66, 8
  s_add_u32 s12, s12, 393216
  v_lshl_add_u32 v226, v2, 3, s12
  s_mov_b32 s13, 100000
L_gl_7:
  buffer_load_dwordx2 v[222:223], v226, s[44:47], 0 offen sc1
  s_waitcnt vmcnt(0)
  v_cmp_ne_u32 vcc, s8, v223
  s_nop 0
  s_cbranch_vccz L_gld_8
  s_sleep 1
  s_sub_u32 s13, s13, 1
  s_cmp_lg_u32 s13, 0
  s_cbranch_scc1 L_gl_7
L_gld_8:
L_gate_ok:
  v_mov_b32 v226, 159744
  s_mov_b32 s12, 1000000
L_lw_9:
  ds_read_b32 v227, v226
  s_waitcnt lgkmcnt(0)
  v_readfirstlane_b32 s13, v227
  s_nop 0
  s_cmp_ge_u32 s13, 4
  s_cbranch_scc1 L_lwd_10
  s_sleep 1
  s_sub_u32 s12, s12, 1
  s_cmp_lg_u32 s12, 0
  s_cbranch_scc1 L_lw_9
L_lwd_10:
  s_add_u32 s12, s3, 1
  s_and_b32 s12, s12, 3
  s_mul_i32 s13, s12, 12288
  s_add_u32 s13, s13, 106496
  v_add_u32 v227, s13, v4
  s_lshl_b32 s12, s12, 9
  s_add_u32 s12, s12, 161024
  v_lshl_add_u32 v231, v2, 2, s12
  ds_write_b128 v227, v[56:59] offset:0
  ds_write_b128 v227, v[60:63] offset:1024
  ds_write_b128 v227, v[64:67] offset:2048
  ds_write_b128 v227, v[68:71] offset:3072
  ds_write_b32 v231, v217
  s_add_u32 s12, s3, 2
  s_and_b32 s12, s12, 3
  s_mul_i32 s13, s12, 12288
  s_add_u32 s13, s13, 102400
  v_add_u32 v228, s13, v4
  s_lshl_b32 s12, s12, 9
  s_add_u32 s12, s12, 160896
  v_lshl_add_u32 v232, v2, 2, s12
  ds_write_b128 v228, v[72:75] offset:0
  ds_write_b128 v228, v[76:79] offset:1024
  ds_write_b128 v228, v[80:83] offset:2048
  ds_write_b128 v228, v[84:87] offset:3072
  ds_write_b32 v232, v218
  s_add_u32 s12, s3, 3
  s_and_b32 s12, s12, 3
  s_mul_i32 s13, s12, 12288
  s_add_u32 s13, s13, 98304
  v_add_u32 v229, s13, v4
  s_lshl_b32 s12, s12, 9
  s_add_u32 s12, s12, 160768
  v_lshl_add_u32 v233, v2, 2, s12
  ds_write_b128 v229, v[88:91] offset:0
  ds_write_b128 v229, v[92:95] offset:1024
  ds_write_b128 v229, v[96:99] offset:2048
  ds_write_b128 v229, v[100:103] offset:3072
  ds_write_b32 v233, v219
  s_mul_i32 s12, s3, 12288
  s_add_u32 s12, s12, 98304
  v_add_u32 v227, s12, v4
  s_lshl_b32 s12, s3, 9
  s_add_u32 s12, s12, 160768
  v_lshl_add_u32 v228, v2, 2, s12
  s_waitcnt lgkmcnt(0)
  v_mov_b32 v229, 159760
  v_mov_b32 v230, 1
  s_mov_b64 exec, 1
  ds_add_u32 v229, v230
  s_mov_b64 exec, -1
  v_mov_b32 v229, 159760
  s_mov_b32 s12, 1000000
L_lw_11:
  ds_read_b32 v230, v229
  s_waitcnt lgkmcnt(0)
  v_readfirstlane_b32 s13, v230
  s_nop 0
  s_cmp_ge_u32 s13, 4
  s_cbranch_scc1 L_lwd_12

  s_sub_u32 s12, s12, 1
  s_cmp_lg_u32 s12, 0
  s_cbranch_scc1 L_lw_11
L_lwd_12:
  ds_read_b32 v217, v228 offset:0
  ds_read_b32 v218, v228 offset:128
  ds_read_b32 v219, v228 offset:256
  ds_read_b128 v[56:59], v227 offset:0
  ds_read_b128 v[60:63], v227 offset:1024
  ds_read_b128 v[64:67], v227 offset:2048
  ds_read_b128 v[68:71], v227 offset:3072
  ds_read_b128 v[72:75], v227 offset:4096
  ds_read_b128 v[76:79], v227 offset:5120
  ds_read_b128 v[80:83], v227 offset:6144
  ds_read_b128 v[84:87], v227 offset:7168
  ds_read_b128 v[88:91], v227 offset:8192
  ds_read_b128 v[92:95], v227 offset:9216
  ds_read_b128 v[96:99], v227 offset:10240
  ds_read_b128 v[100:103], v227 offset:11264
  s_waitcnt lgkmcnt(12)
  v_max3_f32 v224, v216, v217, v218
  v_max_f32 v224, v224, v219
  v_sub_f32 v216, v216, v224
  v_sub_f32 v217, v217, v224
  v_sub_f32 v218, v218, v224
  v_sub_f32 v219, v219, v224
  v_exp_f32 v216, v216
  v_exp_f32 v217, v217
  v_exp_f32 v218, v218
  v_exp_f32 v219, v219
  v_mul_f32 v52, v52, v216
  v_mul_f32 v40, v40, v216
  v_mul_f32 v41, v41, v216
  v_mul_f32 v42, v42, v216
  v_mul_f32 v43, v43, v216
  v_mul_f32 v44, v44, v216
  v_mul_f32 v45, v45, v216
  v_mul_f32 v46, v46, v216
  v_mul_f32 v47, v47, v216
  v_mul_f32 v48, v48, v216
  v_mul_f32 v49, v49, v216
  v_mul_f32 v50, v50, v216
  v_mul_f32 v51, v51, v216
  v_mul_f32 v53, v53, v216
  v_mul_f32 v54, v54, v216
  v_mul_f32 v55, v55, v216
  s_waitcnt lgkmcnt(8)
  v_fmac_f32 v52, v68, v217
  v_fmac_f32 v40, v56, v217
  v_fmac_f32 v41, v57, v217
  v_fmac_f32 v42, v58, v217
  v_fmac_f32 v43, v59, v217
  v_fmac_f32 v44, v60, v217
  v_fmac_f32 v45, v61, v217
  v_fmac_f32 v46, v62, v217
  v_fmac_f32 v47, v63, v217
  v_fmac_f32 v48, v64, v217
  v_fmac_f32 v49, v65, v217
  v_fmac_f32 v50, v66, v217
  v_fmac_f32 v51, v67, v217
  v_fmac_f32 v53, v69, v217
  v_fmac_f32 v54, v70, v217
  v_fmac_f32 v55, v71, v217
  s_waitcnt lgkmcnt(4)
  v_fmac_f32 v52, v84, v218
  v_fmac_f32 v40, v72, v218
  v_fmac_f32 v41, v73, v218
  v_fmac_f32 v42, v74, v218
  v_fmac_f32 v43, v75, v218
  v_fmac_f32 v44, v76, v218
  v_fmac_f32 v45, v77, v218
  v_fmac_f32 v46, v78, v218
  v_fmac_f32 v47, v79, v218
  v_fmac_f32 v48, v80, v218
  v_fmac_f32 v49, v81, v218
  v_fmac_f32 v50, v82, v218
  v_fmac_f32 v51, v83, v218
  v_fmac_f32 v53, v85, v218
  v_fmac_f32 v54, v86, v218
  v_fmac_f32 v55, v87, v218
  s_waitcnt lgkmcnt(0)
  v_fmac_f32 v52, v100, v219
  v_fmac_f32 v40, v88, v219
  v_fmac_f32 v41, v89, v219
  v_fmac_f32 v42, v90, v219
  v_fmac_f32 v43, v91, v219
  v_fmac_f32 v44, v92, v219
  v_fmac_f32 v45, v93, v219
  v_fmac_f32 v46, v94, v219
  v_fmac_f32 v47, v95, v219
  v_fmac_f32 v48, v96, v219
  v_fmac_f32 v49, v97, v219
  v_fmac_f32 v50, v98, v219
  v_fmac_f32 v51, v99, v219
  v_fmac_f32 v53, v101, v219
  v_fmac_f32 v54, v102, v219
  v_fmac_f32 v55, v103, v219
  v_mov_b32 v224, v52
  v_mov_b32 v225, v52
  v_lshlrev_b32 v226, 16, v222
  s_nop 0
  v_permlane32_swap_b32 v224, v225
  v_rcp_f32 v225, v225
  s_nop 0
  v_mul_f32 v225, v225, v226
  v_mul_f32 v40, v40, v225
  v_mul_f32 v41, v41, v225
  v_mul_f32 v42, v42, v225
  v_mul_f32 v43, v43, v225
  v_mul_f32 v44, v44, v225
  v_mul_f32 v45, v45, v225
  v_mul_f32 v46, v46, v225
  v_mul_f32 v47, v47, v225
  v_mul_f32 v48, v48, v225
  v_mul_f32 v49, v49, v225
  v_mul_f32 v50, v50, v225
  v_mul_f32 v51, v51, v225
  v_mul_f32 v52, v52, v225
  v_mul_f32 v53, v53, v225
  v_mul_f32 v54, v54, v225
  v_mul_f32 v55, v55, v225
  v_cvt_pk_bf16_f32 v136, v40, v41
  v_cvt_pk_bf16_f32 v137, v42, v43
  v_cvt_pk_bf16_f32 v138, v44, v45
  v_cvt_pk_bf16_f32 v139, v46, v47
  v_cvt_pk_bf16_f32 v140, v48, v49
  v_cvt_pk_bf16_f32 v141, v50, v51
  v_cvt_pk_bf16_f32 v142, v52, v53
  v_cvt_pk_bf16_f32 v143, v54, v55
  s_mov_b64 exec, s[52:53]
  v_mov_b32 v142, 0
  v_mov_b32 v143, 0
  s_mov_b64 exec, -1
  s_mul_i32 s12, s66, 144
  s_lshl_b32 s13, s64, 1
  s_add_u32 s12, s12, s13
  s_add_u32 s12, s12, 112
  s_lshl_b32 s12, s12, 10
  s_add_u32 s12, s12, 8388608
  buffer_store_dwordx4 v[136:139], v4, s[44:47], s12 offen sc1
  buffer_store_dwordx4 v[140:143], v4, s[44:47], s12 offen offset:1024 sc1
  s_lshl_b32 s12, s66, 4
  s_add_u32 s12, s12, s64
  s_lshl_b32 s12, s12, 7
  s_add_u32 s14, s12, 262144
  s_waitcnt vmcnt(0)
  v_mov_b32 v226, s14
  v_mov_b32 v227, s8
  s_mov_b64 exec, 1
  buffer_store_dword v227, v226, s[44:47], 0 offen sc1
  s_mov_b64 exec, -1
  s_endpgm
L_fwave:
  s_sub_u32 s64, s3, 4
  s_lshl_b32 s76, s10, 1
  s_add_u32 s76, s76, s11
  s_sub_u32 s12, s76, 7
  s_cmp_ge_u32 s76, 7
  s_cselect_b32 s76, s12, s76
  s_lshl_b32 s77, s76, 7
  v_lshrrev_b32 v12, 3, v1
  s_lshl_b32 s12, s6, 7
  s_lshl_b32 s13, s3, 4
  s_add_u32 s12, s12, s13
  s_add_u32 s12, s12, 0
  v_add_u32 v12, s12, v12
  v_mul_u32_u24 v12, 896, v12
  v_lshrrev_b32 v13, 4, v1
  v_add_u32 v13, 0, v13
  v_and_b32 v14, 7, v1
  v_xor_b32 v13, v13, v14
  v_lshl_add_u32 v10, v13, 4, v12
  v_lshrrev_b32 v12, 3, v1
  s_lshl_b32 s12, s6, 7
  s_lshl_b32 s13, s3, 4
  s_add_u32 s12, s12, s13
  s_add_u32 s12, s12, 8
  v_add_u32 v12, s12, v12
  v_mul_u32_u24 v12, 896, v12
  v_lshrrev_b32 v13, 4, v1
  v_add_u32 v13, 4, v13
  v_and_b32 v14, 7, v1
  v_xor_b32 v13, v13, v14
  v_lshl_add_u32 v11, v13, 4, v12
  s_lshl_b32 s58, s3, 11
  s_add_u32 m0, s58, 0
  s_nop 0
  buffer_load_dwordx4 v10, s[16:19], s77 offen lds
  s_add_u32 m0, s58, 1024
  s_nop 0
  buffer_load_dwordx4 v11, s[16:19], s77 offen lds
  s_add_u32 s77, s77, 128
  s_cmp_ge_u32 s77, 896
  s_cselect_b32 s77, 0, s77
  s_mul_i32 s12, s64, 192
  s_add_u32 s12, s12, 0
  v_add_u32 v12, s12, v1
  v_mul_u32_u24 v13, 43691, v12
  v_lshrrev_b32 v13, 19, v13
  v_mul_u32_u24 v14, 12, v13
  v_sub_u32 v12, v12, v14
  v_mul_u32_u24 v13, 2688, v13
  v_lshl_add_u32 v13, v12, 4, v13
  s_lshl_b32 s12, s7, 7
  s_lshl_b32 s13, s7, 6
  s_add_u32 s13, s13, 1664
  v_mov_b32 v14, s12
  v_mov_b32 v15, s13
  v_cmp_gt_u32 vcc, 8, v12
  s_nop 1
  v_cndmask_b32 v14, v15, v14, vcc
  v_add_u32 v21, v13, v14
  s_mul_i32 s12, s64, 192
  s_add_u32 s12, s12, 64
  v_add_u32 v12, s12, v1
  v_mul_u32_u24 v13, 43691, v12
  v_lshrrev_b32 v13, 19, v13
  v_mul_u32_u24 v14, 12, v13
  v_sub_u32 v12, v12, v14
  v_mul_u32_u24 v13, 2688, v13
  v_lshl_add_u32 v13, v12, 4, v13
  s_lshl_b32 s12, s7, 7
  s_lshl_b32 s13, s7, 6
  s_add_u32 s13, s13, 1664
  v_mov_b32 v14, s12
  v_mov_b32 v15, s13
  v_cmp_gt_u32 vcc, 8, v12
  s_nop 1
  v_cndmask_b32 v14, v15, v14, vcc
  v_add_u32 v22, v13, v14
  s_mul_i32 s12, s64, 192
  s_add_u32 s12, s12, 128
  v_add_u32 v12, s12, v1
  v_mul_u32_u24 v13, 43691, v12
  v_lshrrev_b32 v13, 19, v13
  v_mul_u32_u24 v14, 12, v13
  v_sub_u32 v12, v12, v14
  v_mul_u32_u24 v13, 2688, v13
  v_lshl_add_u32 v13, v12, 4, v13
  s_lshl_b32 s12, s7, 7
  s_lshl_b32 s13, s7, 6
  s_add_u32 s13, s13, 1664
  v_mov_b32 v14, s12
  v_mov_b32 v15, s13
  v_cmp_gt_u32 vcc, 8, v12
  s_nop 1
  v_cndmask_b32 v14, v15, v14, vcc
  v_add_u32 v23, v13, v14
  s_mul_i32 s59, s64, 3072
  s_mul_i32 s78, s76, 172032
  s_add_u32 m0, s59, 135168
  s_nop 0
  buffer_load_dwordx4 v21, s[20:23], s78 offen lds
  s_add_u32 m0, s59, 136192
  s_nop 0
  buffer_load_dwordx4 v22, s[20:23], s78 offen lds
  s_add_u32 m0, s59, 137216
  s_nop 0
  buffer_load_dwordx4 v23, s[20:23], s78 offen lds
  s_add_u32 s78, s78, 172032
  s_cmp_ge_u32 s78, 1204224
  s_cselect_b32 s78, 0, s78
  s_barrier
  s_add_u32 m0, s58, 16384
  s_nop 0
  buffer_load_dwordx4 v10, s[16:19], s77 offen lds
  s_add_u32 m0, s58, 17408
  s_nop 0
  buffer_load_dwordx4 v11, s[16:19], s77 offen lds
  s_add_u32 s77, s77, 128
  s_cmp_ge_u32 s77, 896
  s_cselect_b32 s77, 0, s77
  s_add_u32 m0, s59, 147456
  s_nop 0
  buffer_load_dwordx4 v21, s[20:23], s78 offen lds
  s_add_u32 m0, s59, 148480
  s_nop 0
  buffer_load_dwordx4 v22, s[20:23], s78 offen lds
  s_add_u32 m0, s59, 149504
  s_nop 0
  buffer_load_dwordx4 v23, s[20:23], s78 offen lds
  s_add_u32 s78, s78, 172032
  s_cmp_ge_u32 s78, 1204224
  s_cselect_b32 s78, 0, s78
  s_add_u32 m0, s58, 32768
  s_nop 0
  buffer_load_dwordx4 v10, s[16:19], s77 offen lds
  s_add_u32 m0, s58, 33792
  s_nop 0
  buffer_load_dwordx4 v11, s[16:19], s77 offen lds
  s_add_u32 s77, s77, 128
  s_cmp_ge_u32 s77, 896
  s_cselect_b32 s77, 0, s77
  s_add_u32 m0, s59, 98304
  s_nop 0
  buffer_load_dwordx4 v21, s[20:23], s78 offen lds
  s_add_u32 m0, s59, 99328
  s_nop 0
  buffer_load_dwordx4 v22, s[20:23], s78 offen lds
  s_add_u32 m0, s59, 100352
  s_nop 0
  buffer_load_dwordx4 v23, s[20:23], s78 offen lds
  s_add_u32 s78, s78, 172032
  s_cmp_ge_u32 s78, 1204224
  s_cselect_b32 s78, 0, s78
  v_lshrrev_b32 v12, 4, v1
  v_bfe_u32 v13, v1, 2, 2
  v_xor_b32 v13, v13, v12
  v_lshlrev_b32 v13, 6, v13
  v_and_b32 v14, 3, v1
  v_lshl_add_u32 v13, v14, 4, v13
  s_lshl_b32 s12, s64, 2
  v_add_u32 v12, s12, v12
  v_mul_u32_u24 v12, 3584, v12
  s_lshl_b32 s12, s7, 8
  v_add3_u32 v20, v12, v13, s12
  s_mul_i32 s66, s76, 229376
  s_lshl_b32 s67, s64, 10
  s_mul_i32 s68, s64, 24576
  v_bfe_u32 v12, v2, 1, 3
  s_lshl_b32 s12, s64, 12
  v_lshl_add_u32 v13, v2, 7, s12
  v_add_u32 v14, 0, v3
  v_xor_b32 v14, v14, v12
  v_lshl_add_u32 v16, v14, 4, v13
  v_add_u32 v14, 2, v3
  v_xor_b32 v14, v14, v12
  v_lshl_add_u32 v17, v14, 4, v13
  v_add_u32 v14, 4, v3
  v_xor_b32 v14, v14, v12
  v_lshl_add_u32 v18, v14, 4, v13
  v_add_u32 v14, 6, v3
  v_xor_b32 v14, v14, v12
  v_lshl_add_u32 v19, v14, 4, v13
  v_bfe_u32 v12, v1, 2, 2
  v_lshl_add_u32 v13, v3, 3, v12
  v_lshlrev_b32 v13, 8, v13
  v_bfe_u32 v14, v1, 4, 1
  v_lshl_add_u32 v13, v14, 5, v13
  v_and_b32 v14, 3, v1
  v_lshl_add_u32 v13, v14, 3, v13
  v_xor_b32 v14, 0, v12
  v_lshl_add_u32 v14, v14, 6, v13
  v_add_u32 v240, 16384, v14
  v_add_u32 v244, 81920, v14
  v_xor_b32 v14, 1, v12
  v_lshl_add_u32 v14, v14, 6, v13
  v_add_u32 v241, 16384, v14
  v_add_u32 v245, 81920, v14
  v_xor_b32 v14, 2, v12
  v_lshl_add_u32 v14, v14, 6, v13
  v_add_u32 v242, 16384, v14
  v_add_u32 v246, 81920, v14
  v_xor_b32 v14, 3, v12
  v_lshl_add_u32 v14, v14, 6, v13
  v_add_u32 v243, 16384, v14
  v_add_u32 v247, 81920, v14
  s_waitcnt vmcnt(10) lgkmcnt(0)
  v_readfirstlane_b32 s9, v6
  s_nop 0
  s_mul_i32 s8, s9, 0x9E3779B1
  s_xor_b32 s8, s8, 0x5bd1e995
  s_barrier
  ds_read_b128 v[128:131], v16 offset:0
  ds_read_b128 v[132:135], v17 offset:0
  ds_read_b128 v[136:139], v18 offset:0
  ds_read_b128 v[140:143], v19 offset:0
  s_add_u32 m0, s58, 49152
  s_nop 0
  buffer_load_dwordx4 v10, s[16:19], s77 offen lds
  s_add_u32 m0, s58, 50176
  s_nop 0
  buffer_load_dwordx4 v11, s[16:19], s77 offen lds
  s_add_u32 s77, s77, 128
  s_cmp_ge_u32 s77, 896
  s_cselect_b32 s77, 0, s77
  s_add_u32 m0, s59, 110592
  s_nop 0
  buffer_load_dwordx4 v21, s[20:23], s78 offen lds
  s_add_u32 m0, s59, 111616
  s_nop 0
  buffer_load_dwordx4 v22, s[20:23], s78 offen lds
  s_add_u32 m0, s59, 112640
  s_nop 0
  buffer_load_dwordx4 v23, s[20:23], s78 offen lds
  s_add_u32 s78, s78, 172032
  s_cmp_ge_u32 s78, 1204224
  s_cselect_b32 s78, 0, s78
  s_add_u32 m0, s58, 65536
  s_nop 0
  buffer_load_dwordx4 v10, s[16:19], s77 offen lds
  s_add_u32 m0, s58, 66560
  s_nop 0
  buffer_load_dwordx4 v11, s[16:19], s77 offen lds
  s_add_u32 s77, s77, 128
  s_cmp_ge_u32 s77, 896
  s_cselect_b32 s77, 0, s77
  s_add_u32 m0, s59, 122880
  s_nop 0
  buffer_load_dwordx4 v21, s[20:23], s78 offen lds
  s_add_u32 m0, s59, 123904
  s_nop 0
  buffer_load_dwordx4 v22, s[20:23], s78 offen lds
  s_add_u32 m0, s59, 124928
  s_nop 0
  buffer_load_dwordx4 v23, s[20:23], s78 offen lds
  s_add_u32 s78, s78, 172032
  s_cmp_ge_u32 s78, 1204224
  s_cselect_b32 s78, 0, s78
  s_add_u32 m0, s58, 81920
  s_nop 0
  buffer_load_dwordx4 v10, s[16:19], s77 offen lds
  s_add_u32 m0, s58, 82944
  s_nop 0
  buffer_load_dwordx4 v11, s[16:19], s77 offen lds
  s_add_u32 s77, s77, 128
  s_cmp_ge_u32 s77, 896
  s_cselect_b32 s77, 0, s77
  s_waitcnt vmcnt(17) lgkmcnt(0)
  s_barrier
  ds_read_b128 v[144:147], v16 offset:16384
  ds_read_b128 v[148:151], v17 offset:16384
  ds_read_b128 v[152:155], v18 offset:16384
  ds_read_b128 v[156:159], v19 offset:16384
  s_add_u32 m0, s58, 0
  s_nop 0
  buffer_load_dwordx4 v10, s[16:19], s77 offen lds
  s_add_u32 m0, s58, 1024
  s_nop 0
  buffer_load_dwordx4 v11, s[16:19], s77 offen lds
  s_add_u32 s77, s77, 128
  s_cmp_ge_u32 s77, 896
  s_cselect_b32 s77, 0, s77
  s_add_u32 m0, s59, 135168
  s_nop 0
  buffer_load_dwordx4 v21, s[20:23], s78 offen lds
  s_add_u32 m0, s59, 136192
  s_nop 0
  buffer_load_dwordx4 v22, s[20:23], s78 offen lds
  s_add_u32 m0, s59, 137216
  s_nop 0
  buffer_load_dwordx4 v23, s[20:23], s78 offen lds
  s_add_u32 s78, s78, 172032
  s_cmp_ge_u32 s78, 1204224
  s_cselect_b32 s78, 0, s78
  s_waitcnt vmcnt(17) lgkmcnt(0)
  s_barrier
  ds_read_b128 v[160:163], v16 offset:32768
  ds_read_b128 v[164:167], v17 offset:32768
  ds_read_b128 v[168:171], v18 offset:32768
  ds_read_b128 v[172:175], v19 offset:32768
  s_add_u32 m0, s59, 147456
  s_nop 0
  buffer_load_dwordx4 v21, s[20:23], s78 offen lds
  s_add_u32 m0, s59, 148480
  s_nop 0
  buffer_load_dwordx4 v22, s[20:23], s78 offen lds
  s_add_u32 m0, s59, 149504
  s_nop 0
  buffer_load_dwordx4 v23, s[20:23], s78 offen lds
  s_add_u32 s78, s78, 172032
  s_cmp_ge_u32 s78, 1204224
  s_cselect_b32 s78, 0, s78
  s_add_u32 m0, s67, 16384
  s_nop 0
  buffer_load_dwordx4 v20, s[28:31], s66 offen lds
  s_add_u32 s66, s66, 57344
  s_cmp_ge_u32 s66, 1605632
  s_cselect_b32 s66, 0, s66
  s_add_u32 m0, s67, 20480
  s_nop 0
  buffer_load_dwordx4 v20, s[28:31], s66 offen lds
  s_add_u32 s66, s66, 57344
  s_cmp_ge_u32 s66, 1605632
  s_cselect_b32 s66, 0, s66
  s_add_u32 m0, s67, 24576
  s_nop 0
  buffer_load_dwordx4 v20, s[28:31], s66 offen lds
  s_add_u32 s66, s66, 57344
  s_cmp_ge_u32 s66, 1605632
  s_cselect_b32 s66, 0, s66
  s_add_u32 m0, s67, 28672
  s_nop 0
  buffer_load_dwordx4 v20, s[28:31], s66 offen lds
  s_add_u32 s66, s66, 57344
  s_cmp_ge_u32 s66, 1605632
  s_cselect_b32 s66, 0, s66
  s_waitcnt vmcnt(19) lgkmcnt(0)
  s_barrier
  ds_read_b128 v[176:179], v16 offset:49152
  ds_read_b128 v[180:183], v17 offset:49152
  ds_read_b128 v[184:187], v18 offset:49152
  ds_read_b128 v[188:191], v19 offset:49152
  s_add_u32 m0, s67, 32768
  s_nop 0
  buffer_load_dwordx4 v20, s[28:31], s66 offen lds
  s_add_u32 s66, s66, 57344
  s_cmp_ge_u32 s66, 1605632
  s_cselect_b32 s66, 0, s66
  s_add_u32 m0, s67, 36864
  s_nop 0
  buffer_load_dwordx4 v20, s[28:31], s66 offen lds
  s_add_u32 s66, s66, 57344
  s_cmp_ge_u32 s66, 1605632
  s_cselect_b32 s66, 0, s66
  s_add_u32 m0, s67, 40960
  s_nop 0
  buffer_load_dwordx4 v20, s[28:31], s66 offen lds
  s_add_u32 s66, s66, 57344
  s_cmp_ge_u32 s66, 1605632
  s_cselect_b32 s66, 0, s66
  s_add_u32 m0, s67, 45056
  s_nop 0
  buffer_load_dwordx4 v20, s[28:31], s66 offen lds
  s_add_u32 s66, s66, 57344
  s_cmp_ge_u32 s66, 1605632
  s_cselect_b32 s66, 0, s66
  s_waitcnt vmcnt(18) lgkmcnt(0)
  s_barrier
  v_add_u32 v16, 0x10000, v16
  v_add_u32 v17, 0x10000, v17
  v_add_u32 v18, 0x10000, v18
  v_add_u32 v19, 0x10000, v19
  ds_read_b128 v[192:195], v16 offset:0
  ds_read_b128 v[196:199], v17 offset:0
  ds_read_b128 v[200:203], v18 offset:0
  ds_read_b128 v[204:207], v19 offset:0
  s_add_u32 m0, s67, 98304
  s_nop 0
  buffer_load_dwordx4 v20, s[28:31], s66 offen lds
  s_add_u32 s66, s66, 57344
  s_cmp_ge_u32 s66, 1605632
  s_cselect_b32 s66, 0, s66
  s_add_u32 m0, s67, 102400
  s_nop 0
  buffer_load_dwordx4 v20, s[28:31], s66 offen lds
  s_add_u32 s66, s66, 57344
  s_cmp_ge_u32 s66, 1605632
  s_cselect_b32 s66, 0, s66
  s_add_u32 m0, s67, 106496
  s_nop 0
  buffer_load_dwordx4 v20, s[28:31], s66 offen lds
  s_add_u32 s66, s66, 57344
  s_cmp_ge_u32 s66, 1605632
  s_cselect_b32 s66, 0, s66
  s_add_u32 m0, s67, 49152
  s_nop 0
  buffer_load_dwordx4 v20, s[28:31], s66 offen lds
  s_add_u32 s66, s66, 57344
  s_cmp_ge_u32 s66, 1605632
  s_cselect_b32 s66, 0, s66
  s_waitcnt vmcnt(15) lgkmcnt(0)
  s_barrier
  ds_read_b128 v[208:211], v16 offset:16384
  ds_read_b128 v[212:215], v17 offset:16384
  ds_read_b128 v[216:219], v18 offset:16384
  ds_read_b128 v[220:223], v19 offset:16384
  s_add_u32 m0, s67, 53248
  s_nop 0
  buffer_load_dwordx4 v20, s[28:31], s66 offen lds
  s_add_u32 s66, s66, 57344
  s_cmp_ge_u32 s66, 1605632
  s_cselect_b32 s66, 0, s66
  s_add_u32 m0, s67, 57344
  s_nop 0
  buffer_load_dwordx4 v20, s[28:31], s66 offen lds
  s_add_u32 s66, s66, 57344
  s_cmp_ge_u32 s66, 1605632
  s_cselect_b32 s66, 0, s66
  s_add_u32 m0, s67, 61440
  s_nop 0
  buffer_load_dwordx4 v20, s[28:31], s66 offen lds
  s_add_u32 s66, s66, 57344
  s_cmp_ge_u32 s66, 1605632
  s_cselect_b32 s66, 0, s66
  s_add_u32 m0, s67, 110592
  s_nop 0
  buffer_load_dwordx4 v20, s[28:31], s66 offen lds
  s_add_u32 s66, s66, 57344
  s_cmp_ge_u32 s66, 1605632
  s_cselect_b32 s66, 0, s66
  s_waitcnt vmcnt(16) lgkmcnt(0)
  s_barrier
  v_subrev_u32 v16, 0x10000, v16
  v_subrev_u32 v17, 0x10000, v17
  v_subrev_u32 v18, 0x10000, v18
  v_subrev_u32 v19, 0x10000, v19
  ds_read_b128 v[224:227], v16 offset:0
  ds_read_b128 v[228:231], v17 offset:0
  ds_read_b128 v[232:235], v18 offset:0
  ds_read_b128 v[236:239], v19 offset:0
  s_add_u32 m0, s67, 114688
  s_nop 0
  buffer_load_dwordx4 v20, s[28:31], s66 offen lds
  s_add_u32 s66, s66, 57344
  s_cmp_ge_u32 s66, 1605632
  s_cselect_b32 s66, 0, s66
  s_add_u32 m0, s67, 118784
  s_nop 0
  buffer_load_dwordx4 v20, s[28:31], s66 offen lds
  s_add_u32 s66, s66, 57344
  s_cmp_ge_u32 s66, 1605632
  s_cselect_b32 s66, 0, s66
  s_add_u32 m0, s67, 65536
  s_nop 0
  buffer_load_dwordx4 v20, s[28:31], s66 offen lds
  s_add_u32 s66, s66, 57344
  s_cmp_ge_u32 s66, 1605632
  s_cselect_b32 s66, 0, s66
  s_add_u32 m0, s67, 69632
  s_nop 0
  buffer_load_dwordx4 v20, s[28:31], s66 offen lds
  s_add_u32 s66, s66, 57344
  s_cmp_ge_u32 s66, 1605632
  s_cselect_b32 s66, 0, s66
  s_add_u32 m0, s67, 73728
  s_nop 0
  buffer_load_dwordx4 v20, s[28:31], s66 offen lds
  s_add_u32 s66, s66, 57344
  s_cmp_ge_u32 s66, 1605632
  s_cselect_b32 s66, 0, s66
  s_add_u32 m0, s67, 77824
  s_nop 0
  buffer_load_dwordx4 v20, s[28:31], s66 offen lds
  s_add_u32 s66, s66, 57344
  s_cmp_ge_u32 s66, 1605632
  s_cselect_b32 s66, 0, s66
  s_add_u32 m0, s67, 122880
  s_nop 0
  buffer_load_dwordx4 v20, s[28:31], s66 offen lds
  s_add_u32 s66, s66, 57344
  s_cmp_ge_u32 s66, 1605632
  s_cselect_b32 s66, 0, s66
  s_add_u32 m0, s67, 126976
  s_nop 0
  buffer_load_dwordx4 v20, s[28:31], s66 offen lds
  s_add_u32 s66, s66, 57344
  s_cmp_ge_u32 s66, 1605632
  s_cselect_b32 s66, 0, s66
  s_add_u32 m0, s67, 131072
  s_nop 0
  buffer_load_dwordx4 v20, s[28:31], s66 offen lds
  s_add_u32 s66, s66, 57344
  s_cmp_ge_u32 s66, 1605632
  s_cselect_b32 s66, 0, s66
  s_add_u32 m0, s67, 81920
  s_nop 0
  buffer_load_dwordx4 v20, s[28:31], s66 offen lds
  s_add_u32 s66, s66, 57344
  s_cmp_ge_u32 s66, 1605632
  s_cselect_b32 s66, 0, s66
  s_add_u32 m0, s67, 86016
  s_nop 0
  buffer_load_dwordx4 v20, s[28:31], s66 offen lds
  s_add_u32 s66, s66, 57344
  s_cmp_ge_u32 s66, 1605632
  s_cselect_b32 s66, 0, s66
  s_add_u32 m0, s67, 90112
  s_nop 0
  buffer_load_dwordx4 v20, s[28:31], s66 offen lds
  s_add_u32 s66, s66, 57344
  s_cmp_ge_u32 s66, 1605632
  s_cselect_b32 s66, 0, s66
  s_setprio 2
  s_waitcnt vmcnt(12) lgkmcnt(0)
  v_mov_b32 v12, 159764
  v_mov_b32 v13, 1
  s_mov_b64 exec, 1
  ds_add_u32 v12, v13
  s_mov_b64 exec, -1
  v_mov_b32 v12, 159768
  v_mov_b32 v13, 1
  s_mov_b64 exec, 1
  ds_add_u32 v12, v13
  s_mov_b64 exec, -1
  v_mov_b32 v12, 159768
  s_mov_b32 s12, 1000000
L_lw_13:
  ds_read_b32 v13, v12
  s_waitcnt lgkmcnt(0)
  v_readfirstlane_b32 s13, v13
  s_nop 0
  s_cmp_ge_u32 s13, 4
  s_cbranch_scc1 L_lwd_14
  s_sleep 1
  s_sub_u32 s12, s12, 1
  s_cmp_lg_u32 s12, 0
  s_cbranch_scc1 L_lw_13
L_lwd_14:
  ds_read_b64_tr_b16 v[24:25], v240 offset:0
  ds_read_b64_tr_b16 v[26:27], v240 offset:1024
  ds_read_b64_tr_b16 v[28:29], v241 offset:0
  ds_read_b64_tr_b16 v[30:31], v241 offset:1024
  ds_read_b64_tr_b16 v[32:33], v242 offset:0
  ds_read_b64_tr_b16 v[34:35], v242 offset:1024
  ds_read_b64_tr_b16 v[36:37], v243 offset:0
  ds_read_b64_tr_b16 v[38:39], v243 offset:1024
  ds_read_b64_tr_b16 v[40:41], v240 offset:4096
  ds_read_b64_tr_b16 v[42:43], v240 offset:5120
  ds_read_b64_tr_b16 v[44:45], v241 offset:4096
  ds_read_b64_tr_b16 v[46:47], v241 offset:5120
  ds_read_b64_tr_b16 v[48:49], v242 offset:4096
  ds_read_b64_tr_b16 v[50:51], v242 offset:5120
  ds_read_b64_tr_b16 v[52:53], v243 offset:4096
  ds_read_b64_tr_b16 v[54:55], v243 offset:5120
  s_waitcnt lgkmcnt(8)
  v_mfma_f32_32x32x16_bf16 v[64:79], v[24:27], v[128:131], 0
  v_mfma_f32_32x32x16_bf16 v[80:95], v[28:31], v[128:131], 0
  v_mfma_f32_32x32x16_bf16 v[96:111], v[32:35], v[128:131], 0
  v_mfma_f32_32x32x16_bf16 v[112:127], v[36:39], v[128:131], 0
  ds_read_b64_tr_b16 v[24:25], v240 offset:8192
  ds_read_b64_tr_b16 v[26:27], v240 offset:9216
  ds_read_b64_tr_b16 v[28:29], v241 offset:8192
  ds_read_b64_tr_b16 v[30:31], v241 offset:9216
  ds_read_b64_tr_b16 v[32:33], v242 offset:8192
  ds_read_b64_tr_b16 v[34:35], v242 offset:9216
  ds_read_b64_tr_b16 v[36:37], v243 offset:8192
  ds_read_b64_tr_b16 v[38:39], v243 offset:9216
  s_waitcnt lgkmcnt(8)
  v_mfma_f32_32x32x16_bf16 v[64:79], v[40:43], v[132:135], v[64:79]
  v_mfma_f32_32x32x16_bf16 v[80:95], v[44:47], v[132:135], v[80:95]
  v_mfma_f32_32x32x16_bf16 v[96:111], v[48:51], v[132:135], v[96:111]
  v_mfma_f32_32x32x16_bf16 v[112:127], v[52:55], v[132:135], v[112:127]
  ds_read_b64_tr_b16 v[40:41], v240 offset:12288
  ds_read_b64_tr_b16 v[42:43], v240 offset:13312
  ds_read_b64_tr_b16 v[44:45], v241 offset:12288
  ds_read_b64_tr_b16 v[46:47], v241 offset:13312
  ds_read_b64_tr_b16 v[48:49], v242 offset:12288
  ds_read_b64_tr_b16 v[50:51], v242 offset:13312
  ds_read_b64_tr_b16 v[52:53], v243 offset:12288
  ds_read_b64_tr_b16 v[54:55], v243 offset:13312
  s_waitcnt lgkmcnt(8)
  v_mfma_f32_32x32x16_bf16 v[64:79], v[24:27], v[136:139], v[64:79]
  v_mfma_f32_32x32x16_bf16 v[80:95], v[28:31], v[136:139], v[80:95]
  v_mfma_f32_32x32x16_bf16 v[96:111], v[32:35], v[136:139], v[96:111]
  v_mfma_f32_32x32x16_bf16 v[112:127], v[36:39], v[136:139], v[112:127]
  ds_read_b64_tr_b16 v[24:25], v240 offset:16384
  ds_read_b64_tr_b16 v[26:27], v240 offset:17408
  ds_read_b64_tr_b16 v[28:29], v241 offset:16384
  ds_read_b64_tr_b16 v[30:31], v241 offset:17408
  ds_read_b64_tr_b16 v[32:33], v242 offset:16384
  ds_read_b64_tr_b16 v[34:35], v242 offset:17408
  ds_read_b64_tr_b16 v[36:37], v243 offset:16384
  ds_read_b64_tr_b16 v[38:39], v243 offset:17408
  s_waitcnt lgkmcnt(8)
  v_mfma_f32_32x32x16_bf16 v[64:79], v[40:43], v[140:143], v[64:79]
  v_mfma_f32_32x32x16_bf16 v[80:95], v[44:47], v[140:143], v[80:95]
  v_mfma_f32_32x32x16_bf16 v[96:111], v[48:51], v[140:143], v[96:111]
  v_mfma_f32_32x32x16_bf16 v[112:127], v[52:55], v[140:143], v[112:127]
  s_waitcnt vmcnt(0)
  v_mov_b32 v12, 159772
  v_mov_b32 v13, 1
  s_mov_b64 exec, 1
  ds_add_u32 v12, v13
  s_mov_b64 exec, -1
  ds_read_b64_tr_b16 v[40:41], v240 offset:20480
  ds_read_b64_tr_b16 v[42:43], v240 offset:21504
  ds_read_b64_tr_b16 v[44:45], v241 offset:20480
  ds_read_b64_tr_b16 v[46:47], v241 offset:21504
  ds_read_b64_tr_b16 v[48:49], v242 offset:20480
  ds_read_b64_tr_b16 v[50:51], v242 offset:21504
  ds_read_b64_tr_b16 v[52:53], v243 offset:20480
  ds_read_b64_tr_b16 v[54:55], v243 offset:21504
  s_waitcnt lgkmcnt(8)
  v_mfma_f32_32x32x16_bf16 v[64:79], v[24:27], v[144:147], v[64:79]
  v_mfma_f32_32x32x16_bf16 v[80:95], v[28:31], v[144:147], v[80:95]
  v_mfma_f32_32x32x16_bf16 v[96:111], v[32:35], v[144:147], v[96:111]
  v_mfma_f32_32x32x16_bf16 v[112:127], v[36:39], v[144:147], v[112:127]
  ds_read_b64_tr_b16 v[24:25], v240 offset:24576
  ds_read_b64_tr_b16 v[26:27], v240 offset:25600
  ds_read_b64_tr_b16 v[28:29], v241 offset:24576
  ds_read_b64_tr_b16 v[30:31], v241 offset:25600
  ds_read_b64_tr_b16 v[32:33], v242 offset:24576
  ds_read_b64_tr_b16 v[34:35], v242 offset:25600
  ds_read_b64_tr_b16 v[36:37], v243 offset:24576
  ds_read_b64_tr_b16 v[38:39], v243 offset:25600
  s_waitcnt lgkmcnt(8)
  v_mfma_f32_32x32x16_bf16 v[64:79], v[40:43], v[148:151], v[64:79]
  v_mfma_f32_32x32x16_bf16 v[80:95], v[44:47], v[148:151], v[80:95]
  v_mfma_f32_32x32x16_bf16 v[96:111], v[48:51], v[148:151], v[96:111]
  v_mfma_f32_32x32x16_bf16 v[112:127], v[52:55], v[148:151], v[112:127]
  ds_read_b64_tr_b16 v[40:41], v240 offset:28672
  ds_read_b64_tr_b16 v[42:43], v240 offset:29696
  ds_read_b64_tr_b16 v[44:45], v241 offset:28672
  ds_read_b64_tr_b16 v[46:47], v241 offset:29696
  ds_read_b64_tr_b16 v[48:49], v242 offset:28672
  ds_read_b64_tr_b16 v[50:51], v242 offset:29696
  ds_read_b64_tr_b16 v[52:53], v243 offset:28672
  ds_read_b64_tr_b16 v[54:55], v243 offset:29696
  s_waitcnt lgkmcnt(8)
  v_mfma_f32_32x32x16_bf16 v[64:79], v[24:27], v[152:155], v[64:79]
  v_mfma_f32_32x32x16_bf16 v[80:95], v[28:31], v[152:155], v[80:95]
  v_mfma_f32_32x32x16_bf16 v[96:111], v[32:35], v[152:155], v[96:111]
  v_mfma_f32_32x32x16_bf16 v[112:127], v[36:39], v[152:155], v[112:127]
  ds_read_b64_tr_b16 v[24:25], v244 offset:16384
  ds_read_b64_tr_b16 v[26:27], v244 offset:17408
  ds_read_b64_tr_b16 v[28:29], v245 offset:16384
  ds_read_b64_tr_b16 v[30:31], v245 offset:17408
  ds_read_b64_tr_b16 v[32:33], v246 offset:16384
  ds_read_b64_tr_b16 v[34:35], v246 offset:17408
  ds_read_b64_tr_b16 v[36:37], v247 offset:16384
  ds_read_b64_tr_b16 v[38:39], v247 offset:17408
  s_waitcnt lgkmcnt(8)
  v_mfma_f32_32x32x16_bf16 v[64:79], v[40:43], v[156:159], v[64:79]
  v_mfma_f32_32x32x16_bf16 v[80:95], v[44:47], v[156:159], v[80:95]
  v_mfma_f32_32x32x16_bf16 v[96:111], v[48:51], v[156:159], v[96:111]
  v_mfma_f32_32x32x16_bf16 v[112:127], v[52:55], v[156:159], v[112:127]
  ds_read_b64_tr_b16 v[40:41], v244 offset:20480
  ds_read_b64_tr_b16 v[42:43], v244 offset:21504
  ds_read_b64_tr_b16 v[44:45], v245 offset:20480
  ds_read_b64_tr_b16 v[46:47], v245 offset:21504
  ds_read_b64_tr_b16 v[48:49], v246 offset:20480
  ds_read_b64_tr_b16 v[50:51], v246 offset:21504
  ds_read_b64_tr_b16 v[52:53], v247 offset:20480
  ds_read_b64_tr_b16 v[54:55], v247 offset:21504
  s_waitcnt lgkmcnt(8)
  v_mfma_f32_32x32x16_bf16 v[64:79], v[24:27], v[160:163], v[64:79]
  v_mfma_f32_32x32x16_bf16 v[80:95], v[28:31], v[160:163], v[80:95]
  v_mfma_f32_32x32x16_bf16 v[96:111], v[32:35], v[160:163], v[96:111]
  v_mfma_f32_32x32x16_bf16 v[112:127], v[36:39], v[160:163], v[112:127]
  ds_read_b64_tr_b16 v[24:25], v244 offset:24576
  ds_read_b64_tr_b16 v[26:27], v244 offset:25600
  ds_read_b64_tr_b16 v[28:29], v245 offset:24576
  ds_read_b64_tr_b16 v[30:31], v245 offset:25600
  ds_read_b64_tr_b16 v[32:33], v246 offset:24576
  ds_read_b64_tr_b16 v[34:35], v246 offset:25600
  ds_read_b64_tr_b16 v[36:37], v247 offset:24576
  ds_read_b64_tr_b16 v[38:39], v247 offset:25600
  s_waitcnt lgkmcnt(8)
  v_mfma_f32_32x32x16_bf16 v[64:79], v[40:43], v[164:167], v[64:79]
  v_mfma_f32_32x32x16_bf16 v[80:95], v[44:47], v[164:167], v[80:95]
  v_mfma_f32_32x32x16_bf16 v[96:111], v[48:51], v[164:167], v[96:111]
  v_mfma_f32_32x32x16_bf16 v[112:127], v[52:55], v[164:167], v[112:127]
  ds_read_b64_tr_b16 v[40:41], v240 offset:32768
  ds_read_b64_tr_b16 v[42:43], v240 offset:33792
  ds_read_b64_tr_b16 v[44:45], v241 offset:32768
  ds_read_b64_tr_b16 v[46:47], v241 offset:33792
  ds_read_b64_tr_b16 v[48:49], v242 offset:32768
  ds_read_b64_tr_b16 v[50:51], v242 offset:33792
  ds_read_b64_tr_b16 v[52:53], v243 offset:32768
  ds_read_b64_tr_b16 v[54:55], v243 offset:33792
  s_waitcnt lgkmcnt(8)
  v_mfma_f32_32x32x16_bf16 v[64:79], v[24:27], v[168:171], v[64:79]
  v_mfma_f32_32x32x16_bf16 v[80:95], v[28:31], v[168:171], v[80:95]
  v_mfma_f32_32x32x16_bf16 v[96:111], v[32:35], v[168:171], v[96:111]
  v_mfma_f32_32x32x16_bf16 v[112:127], v[36:39], v[168:171], v[112:127]
  ds_read_b64_tr_b16 v[24:25], v240 offset:36864
  ds_read_b64_tr_b16 v[26:27], v240 offset:37888
  ds_read_b64_tr_b16 v[28:29], v241 offset:36864
  ds_read_b64_tr_b16 v[30:31], v241 offset:37888
  ds_read_b64_tr_b16 v[32:33], v242 offset:36864
  ds_read_b64_tr_b16 v[34:35], v242 offset:37888
  ds_read_b64_tr_b16 v[36:37], v243 offset:36864
  ds_read_b64_tr_b16 v[38:39], v243 offset:37888
  s_waitcnt lgkmcnt(8)
  v_mfma_f32_32x32x16_bf16 v[64:79], v[40:43], v[172:175], v[64:79]
  v_mfma_f32_32x32x16_bf16 v[80:95], v[44:47], v[172:175], v[80:95]
  v_mfma_f32_32x32x16_bf16 v[96:111], v[48:51], v[172:175], v[96:111]
  v_mfma_f32_32x32x16_bf16 v[112:127], v[52:55], v[172:175], v[112:127]
  ds_read_b64_tr_b16 v[40:41], v240 offset:40960
  ds_read_b64_tr_b16 v[42:43], v240 offset:41984
  ds_read_b64_tr_b16 v[44:45], v241 offset:40960
  ds_read_b64_tr_b16 v[46:47], v241 offset:41984
  ds_read_b64_tr_b16 v[48:49], v242 offset:40960
  ds_read_b64_tr_b16 v[50:51], v242 offset:41984
  ds_read_b64_tr_b16 v[52:53], v243 offset:40960
  ds_read_b64_tr_b16 v[54:55], v243 offset:41984
  s_waitcnt lgkmcnt(8)
  v_mfma_f32_32x32x16_bf16 v[64:79], v[24:27], v[176:179], v[64:79]
  v_mfma_f32_32x32x16_bf16 v[80:95], v[28:31], v[176:179], v[80:95]
  v_mfma_f32_32x32x16_bf16 v[96:111], v[32:35], v[176:179], v[96:111]
  v_mfma_f32_32x32x16_bf16 v[112:127], v[36:39], v[176:179], v[112:127]
  ds_read_b64_tr_b16 v[24:25], v240 offset:45056
  ds_read_b64_tr_b16 v[26:27], v240 offset:46080
  ds_read_b64_tr_b16 v[28:29], v241 offset:45056
  ds_read_b64_tr_b16 v[30:31], v241 offset:46080
  ds_read_b64_tr_b16 v[32:33], v242 offset:45056
  ds_read_b64_tr_b16 v[34:35], v242 offset:46080
  ds_read_b64_tr_b16 v[36:37], v243 offset:45056
  ds_read_b64_tr_b16 v[38:39], v243 offset:46080
  s_waitcnt lgkmcnt(8)
  v_mfma_f32_32x32x16_bf16 v[64:79], v[40:43], v[180:183], v[64:79]
  v_mfma_f32_32x32x16_bf16 v[80:95], v[44:47], v[180:183], v[80:95]
  v_mfma_f32_32x32x16_bf16 v[96:111], v[48:51], v[180:183], v[96:111]
  v_mfma_f32_32x32x16_bf16 v[112:127], v[52:55], v[180:183], v[112:127]
  ds_read_b64_tr_b16 v[40:41], v244 offset:28672
  ds_read_b64_tr_b16 v[42:43], v244 offset:29696
  ds_read_b64_tr_b16 v[44:45], v245 offset:28672
  ds_read_b64_tr_b16 v[46:47], v245 offset:29696
  ds_read_b64_tr_b16 v[48:49], v246 offset:28672
  ds_read_b64_tr_b16 v[50:51], v246 offset:29696
  ds_read_b64_tr_b16 v[52:53], v247 offset:28672
  ds_read_b64_tr_b16 v[54:55], v247 offset:29696
  s_waitcnt lgkmcnt(8)
  v_mfma_f32_32x32x16_bf16 v[64:79], v[24:27], v[184:187], v[64:79]
  v_mfma_f32_32x32x16_bf16 v[80:95], v[28:31], v[184:187], v[80:95]
  v_mfma_f32_32x32x16_bf16 v[96:111], v[32:35], v[184:187], v[96:111]
  v_mfma_f32_32x32x16_bf16 v[112:127], v[36:39], v[184:187], v[112:127]
  v_mov_b32 v12, 159772
  s_mov_b32 s12, 1000000
L_lw_15:
  ds_read_b32 v13, v12
  s_waitcnt lgkmcnt(0)
  v_readfirstlane_b32 s13, v13
  s_nop 0
  s_cmp_ge_u32 s13, 4
  s_cbranch_scc1 L_lwd_16
  s_sleep 1
  s_sub_u32 s12, s12, 1
  s_cmp_lg_u32 s12, 0
  s_cbranch_scc1 L_lw_15
L_lwd_16:
  s_waitcnt lgkmcnt(0)
  v_mfma_f32_32x32x16_bf16 v[64:79], v[40:43], v[188:191], v[64:79]
  v_mfma_f32_32x32x16_bf16 v[80:95], v[44:47], v[188:191], v[80:95]
  v_mfma_f32_32x32x16_bf16 v[96:111], v[48:51], v[188:191], v[96:111]
  v_mfma_f32_32x32x16_bf16 v[112:127], v[52:55], v[188:191], v[112:127]
  s_mov_b32 s83, 3216550459
  ds_read_b64_tr_b16 v[24:25], v244 offset:32768
  ds_read_b64_tr_b16 v[26:27], v244 offset:33792
  ds_read_b64_tr_b16 v[28:29], v244 offset:36864
  ds_read_b64_tr_b16 v[30:31], v244 offset:37888
  ds_read_b64_tr_b16 v[32:33], v240 offset:49152
  ds_read_b64_tr_b16 v[34:35], v240 offset:50176
  ds_read_b64_tr_b16 v[36:37], v240 offset:53248
  ds_read_b64_tr_b16 v[38:39], v240 offset:54272
  ds_read_b64_tr_b16 v[40:41], v240 offset:57344
  ds_read_b64_tr_b16 v[42:43], v240 offset:58368
  ds_read_b64_tr_b16 v[44:45], v240 offset:61440
  ds_read_b64_tr_b16 v[46:47], v240 offset:62464
  s_waitcnt lgkmcnt(10)
  v_mfma_f32_32x32x16_bf16 v[64:79], v[24:27], v[192:195], v[64:79]
  ds_read_b64_tr_b16 v[48:49], v244 offset:40960
  ds_read_b64_tr_b16 v[50:51], v244 offset:41984
  s_waitcnt lgkmcnt(10)
  v_mfma_f32_32x32x16_bf16 v[64:79], v[28:31], v[196:199], v[64:79]
  ds_read_b64_tr_b16 v[52:53], v244 offset:45056
  ds_read_b64_tr_b16 v[54:55], v244 offset:46080
  s_waitcnt lgkmcnt(10)
  v_mfma_f32_32x32x16_bf16 v[64:79], v[32:35], v[200:203], v[64:79]
  ds_read_b64_tr_b16 v[24:25], v244 offset:49152
  ds_read_b64_tr_b16 v[26:27], v244 offset:50176
  s_waitcnt lgkmcnt(10)
  v_mfma_f32_32x32x16_bf16 v[64:79], v[36:39], v[204:207], v[64:79]
  ds_read_b64_tr_b16 v[28:29], v244 offset:0
  ds_read_b64_tr_b16 v[30:31], v244 offset:1024
  s_waitcnt lgkmcnt(10)
  v_mfma_f32_32x32x16_bf16 v[64:79], v[40:43], v[208:211], v[64:79]
  ds_read_b64_tr_b16 v[32:33], v244 offset:4096
  ds_read_b64_tr_b16 v[34:35], v244 offset:5120
  s_waitcnt lgkmcnt(10)
  v_mfma_f32_32x32x16_bf16 v[64:79], v[44:47], v[212:215], v[64:79]
  ds_read_b64_tr_b16 v[36:37], v244 offset:8192
  ds_read_b64_tr_b16 v[38:39], v244 offset:9216
  s_waitcnt lgkmcnt(10)
  v_mfma_f32_32x32x16_bf16 v[64:79], v[48:51], v[216:219], v[64:79]
  ds_read_b64_tr_b16 v[40:41], v245 offset:32768
  ds_read_b64_tr_b16 v[42:43], v245 offset:33792
  s_waitcnt lgkmcnt(10)
  v_mfma_f32_32x32x16_bf16 v[64:79], v[52:55], v[220:223], v[64:79]
  ds_read_b64_tr_b16 v[44:45], v245 offset:36864
  ds_read_b64_tr_b16 v[46:47], v245 offset:37888
  s_waitcnt lgkmcnt(10)
  v_mfma_f32_32x32x16_bf16 v[64:79], v[24:27], v[224:227], v[64:79]
  ds_read_b64_tr_b16 v[48:49], v241 offset:49152
  ds_read_b64_tr_b16 v[50:51], v241 offset:50176
  s_waitcnt lgkmcnt(10)
  v_mfma_f32_32x32x16_bf16 v[64:79], v[28:31], v[228:231], v[64:79]
  ds_read_b64_tr_b16 v[52:53], v241 offset:53248
  ds_read_b64_tr_b16 v[54:55], v241 offset:54272
  s_waitcnt lgkmcnt(10)
  v_mfma_f32_32x32x16_bf16 v[64:79], v[32:35], v[232:235], v[64:79]
  ds_read_b64_tr_b16 v[24:25], v241 offset:57344
  ds_read_b64_tr_b16 v[26:27], v241 offset:58368
  s_waitcnt lgkmcnt(10)
  v_mfma_f32_32x32x16_bf16 v[64:79], v[36:39], v[236:239], v[64:79]
  ds_read_b64_tr_b16 v[28:29], v241 offset:61440
  ds_read_b64_tr_b16 v[30:31], v241 offset:62464
  s_waitcnt lgkmcnt(10)
  v_mfma_f32_32x32x16_bf16 v[80:95], v[40:43], v[192:195], v[80:95]
  ds_read_b64_tr_b16 v[32:33], v245 offset:40960
  ds_read_b64_tr_b16 v[34:35], v245 offset:41984
  s_waitcnt lgkmcnt(10)
  v_mfma_f32_32x32x16_bf16 v[80:95], v[44:47], v[196:199], v[80:95]
  s_nop 3
  v_mul_f32 v128, s83, v64
  v_mul_f32 v129, s83, v65
  v_mul_f32 v130, s83, v66
  v_mul_f32 v131, s83, v67
  v_mul_f32 v132, s83, v68
  v_mul_f32 v133, s83, v69
  v_mul_f32 v134, s83, v70
  v_mul_f32 v135, s83, v71
  ds_read_b64_tr_b16 v[36:37], v245 offset:45056
  ds_read_b64_tr_b16 v[38:39], v245 offset:46080
  s_waitcnt lgkmcnt(10)
  v_mfma_f32_32x32x16_bf16 v[80:95], v[48:51], v[200:203], v[80:95]
  v_exp_f32 v128, v128
  v_exp_f32 v129, v129
  v_exp_f32 v130, v130
  v_exp_f32 v131, v131
  v_exp_f32 v132, v132
  v_exp_f32 v133, v133
  v_exp_f32 v134, v134
  v_exp_f32 v135, v135
  ds_read_b64_tr_b16 v[40:41], v245 offset:49152
  ds_read_b64_tr_b16 v[42:43], v245 offset:50176
  s_waitcnt lgkmcnt(10)
  v_mfma_f32_32x32x16_bf16 v[80:95], v[52:55], v[204:207], v[80:95]
  v_add_f32 v128, 1.0, v128
  v_add_f32 v129, 1.0, v129
  v_add_f32 v130, 1.0, v130
  v_add_f32 v131, 1.0, v131
  v_add_f32 v132, 1.0, v132
  v_add_f32 v133, 1.0, v133
  v_add_f32 v134, 1.0, v134
  v_add_f32 v135, 1.0, v135
  ds_read_b64_tr_b16 v[44:45], v245 offset:0
  ds_read_b64_tr_b16 v[46:47], v245 offset:1024
  s_waitcnt lgkmcnt(10)
  v_mfma_f32_32x32x16_bf16 v[80:95], v[24:27], v[208:211], v[80:95]
  v_rcp_f32 v128, v128
  v_rcp_f32 v129, v129
  v_rcp_f32 v130, v130
  v_rcp_f32 v131, v131
  v_rcp_f32 v132, v132
  v_rcp_f32 v133, v133
  v_rcp_f32 v134, v134
  v_rcp_f32 v135, v135
  ds_read_b64_tr_b16 v[48:49], v245 offset:4096
  ds_read_b64_tr_b16 v[50:51], v245 offset:5120
  s_waitcnt lgkmcnt(10)
  v_mfma_f32_32x32x16_bf16 v[80:95], v[28:31], v[212:215], v[80:95]
  v_mul_f32 v128, v128, v64
  v_mul_f32 v129, v129, v65
  v_mul_f32 v130, v130, v66
  v_mul_f32 v131, v131, v67
  v_mul_f32 v132, v132, v68
  v_mul_f32 v133, v133, v69
  v_mul_f32 v134, v134, v70
  v_mul_f32 v135, v135, v71
  ds_read_b64_tr_b16 v[52:53], v245 offset:8192
  ds_read_b64_tr_b16 v[54:55], v245 offset:9216
  s_waitcnt lgkmcnt(10)
  v_mfma_f32_32x32x16_bf16 v[80:95], v[32:35], v[216:219], v[80:95]
  v_cvt_pk_bf16_f32 v144, v128, v129
  v_cvt_pk_bf16_f32 v145, v130, v131
  v_cvt_pk_bf16_f32 v146, v132, v133
  v_cvt_pk_bf16_f32 v147, v134, v135
  v_mul_f32 v136, s83, v72
  v_mul_f32 v137, s83, v73
  v_mul_f32 v138, s83, v74
  v_mul_f32 v139, s83, v75
  ds_read_b64_tr_b16 v[24:25], v246 offset:32768
  ds_read_b64_tr_b16 v[26:27], v246 offset:33792
  s_waitcnt lgkmcnt(10)
  v_mfma_f32_32x32x16_bf16 v[80:95], v[36:39], v[220:223], v[80:95]
  v_mul_f32 v140, s83, v76
  v_mul_f32 v141, s83, v77
  v_mul_f32 v142, s83, v78
  v_mul_f32 v143, s83, v79
  v_exp_f32 v136, v136
  v_exp_f32 v137, v137
  v_exp_f32 v138, v138
  v_exp_f32 v139, v139
  ds_read_b64_tr_b16 v[28:29], v246 offset:36864
  ds_read_b64_tr_b16 v[30:31], v246 offset:37888
  s_waitcnt lgkmcnt(10)
  v_mfma_f32_32x32x16_bf16 v[80:95], v[40:43], v[224:227], v[80:95]
  v_exp_f32 v140, v140
  v_exp_f32 v141, v141
  v_exp_f32 v142, v142
  v_exp_f32 v143, v143
  v_add_f32 v136, 1.0, v136
  v_add_f32 v137, 1.0, v137
  v_add_f32 v138, 1.0, v138
  v_add_f32 v139, 1.0, v139
  ds_read_b64_tr_b16 v[32:33], v242 offset:49152
  ds_read_b64_tr_b16 v[34:35], v242 offset:50176
  s_waitcnt lgkmcnt(10)
  v_mfma_f32_32x32x16_bf16 v[80:95], v[44:47], v[228:231], v[80:95]
  v_add_f32 v140, 1.0, v140
  v_add_f32 v141, 1.0, v141
  v_add_f32 v142, 1.0, v142
  v_add_f32 v143, 1.0, v143
  v_rcp_f32 v136, v136
  v_rcp_f32 v137, v137
  v_rcp_f32 v138, v138
  v_rcp_f32 v139, v139
  ds_read_b64_tr_b16 v[36:37], v242 offset:53248
  ds_read_b64_tr_b16 v[38:39], v242 offset:54272
  s_waitcnt lgkmcnt(10)
  v_mfma_f32_32x32x16_bf16 v[80:95], v[48:51], v[232:235], v[80:95]
  v_rcp_f32 v140, v140
  v_rcp_f32 v141, v141
  v_rcp_f32 v142, v142
  v_rcp_f32 v143, v143
  v_mul_f32 v136, v136, v72
  v_mul_f32 v137, v137, v73
  v_mul_f32 v138, v138, v74
  v_mul_f32 v139, v139, v75
  ds_read_b64_tr_b16 v[40:41], v242 offset:57344
  ds_read_b64_tr_b16 v[42:43], v242 offset:58368
  s_waitcnt lgkmcnt(10)
  v_mfma_f32_32x32x16_bf16 v[80:95], v[52:55], v[236:239], v[80:95]
  v_mul_f32 v140, v140, v76
  v_mul_f32 v141, v141, v77
  v_mul_f32 v142, v142, v78
  v_mul_f32 v143, v143, v79
  v_cvt_pk_bf16_f32 v148, v136, v137
  v_cvt_pk_bf16_f32 v149, v138, v139
  v_cvt_pk_bf16_f32 v150, v140, v141
  v_cvt_pk_bf16_f32 v151, v142, v143
  ds_read_b64_tr_b16 v[44:45], v242 offset:61440
  ds_read_b64_tr_b16 v[46:47], v242 offset:62464
  s_waitcnt lgkmcnt(10)
  v_mfma_f32_32x32x16_bf16 v[96:111], v[24:27], v[192:195], v[96:111]
  ds_read_b64_tr_b16 v[48:49], v246 offset:40960
  ds_read_b64_tr_b16 v[50:51], v246 offset:41984
  s_waitcnt lgkmcnt(10)
  v_mfma_f32_32x32x16_bf16 v[96:111], v[28:31], v[196:199], v[96:111]
  v_mul_f32 v128, s83, v80
  v_mul_f32 v129, s83, v81
  v_mul_f32 v130, s83, v82
  v_mul_f32 v131, s83, v83
  v_mul_f32 v132, s83, v84
  v_mul_f32 v133, s83, v85
  v_mul_f32 v134, s83, v86
  v_mul_f32 v135, s83, v87
  ds_read_b64_tr_b16 v[52:53], v246 offset:45056
  ds_read_b64_tr_b16 v[54:55], v246 offset:46080
  s_waitcnt lgkmcnt(10)
  v_mfma_f32_32x32x16_bf16 v[96:111], v[32:35], v[200:203], v[96:111]
  v_exp_f32 v128, v128
  v_exp_f32 v129, v129
  v_exp_f32 v130, v130
  v_exp_f32 v131, v131
  v_exp_f32 v132, v132
  v_exp_f32 v133, v133
  v_exp_f32 v134, v134
  v_exp_f32 v135, v135
  ds_read_b64_tr_b16 v[24:25], v246 offset:49152
  ds_read_b64_tr_b16 v[26:27], v246 offset:50176
  s_waitcnt lgkmcnt(10)
  v_mfma_f32_32x32x16_bf16 v[96:111], v[36:39], v[204:207], v[96:111]
  v_add_f32 v128, 1.0, v128
  v_add_f32 v129, 1.0, v129
  v_add_f32 v130, 1.0, v130
  v_add_f32 v131, 1.0, v131
  v_add_f32 v132, 1.0, v132
  v_add_f32 v133, 1.0, v133
  v_add_f32 v134, 1.0, v134
  v_add_f32 v135, 1.0, v135
  ds_read_b64_tr_b16 v[28:29], v246 offset:0
  ds_read_b64_tr_b16 v[30:31], v246 offset:1024
  s_waitcnt lgkmcnt(10)
  v_mfma_f32_32x32x16_bf16 v[96:111], v[40:43], v[208:211], v[96:111]
  v_rcp_f32 v128, v128
  v_rcp_f32 v129, v129
  v_rcp_f32 v130, v130
  v_rcp_f32 v131, v131
  v_rcp_f32 v132, v132
  v_rcp_f32 v133, v133
  v_rcp_f32 v134, v134
  v_rcp_f32 v135, v135
  ds_read_b64_tr_b16 v[32:33], v246 offset:4096
  ds_read_b64_tr_b16 v[34:35], v246 offset:5120
  s_waitcnt lgkmcnt(10)
  v_mfma_f32_32x32x16_bf16 v[96:111], v[44:47], v[212:215], v[96:111]
  v_mul_f32 v128, v128, v80
  v_mul_f32 v129, v129, v81
  v_mul_f32 v130, v130, v82
  v_mul_f32 v131, v131, v83
  v_mul_f32 v132, v132, v84
  v_mul_f32 v133, v133, v85
  v_mul_f32 v134, v134, v86
  v_mul_f32 v135, v135, v87
  ds_read_b64_tr_b16 v[36:37], v246 offset:8192
  ds_read_b64_tr_b16 v[38:39], v246 offset:9216
  s_waitcnt lgkmcnt(10)
  v_mfma_f32_32x32x16_bf16 v[96:111], v[48:51], v[216:219], v[96:111]
  v_cvt_pk_bf16_f32 v152, v128, v129
  v_cvt_pk_bf16_f32 v153, v130, v131
  v_cvt_pk_bf16_f32 v154, v132, v133
  v_cvt_pk_bf16_f32 v155, v134, v135
  v_mul_f32 v136, s83, v88
  v_mul_f32 v137, s83, v89
  v_mul_f32 v138, s83, v90
  v_mul_f32 v139, s83, v91
  ds_read_b64_tr_b16 v[40:41], v247 offset:32768
  ds_read_b64_tr_b16 v[42:43], v247 offset:33792
  s_waitcnt lgkmcnt(10)
  v_mfma_f32_32x32x16_bf16 v[96:111], v[52:55], v[220:223], v[96:111]
  v_mul_f32 v140, s83, v92
  v_mul_f32 v141, s83, v93
  v_mul_f32 v142, s83, v94
  v_mul_f32 v143, s83, v95
  v_exp_f32 v136, v136
  v_exp_f32 v137, v137
  v_exp_f32 v138, v138
  v_exp_f32 v139, v139
  ds_read_b64_tr_b16 v[44:45], v247 offset:36864
  ds_read_b64_tr_b16 v[46:47], v247 offset:37888
  s_waitcnt lgkmcnt(10)
  v_mfma_f32_32x32x16_bf16 v[96:111], v[24:27], v[224:227], v[96:111]
  v_exp_f32 v140, v140
  v_exp_f32 v141, v141
  v_exp_f32 v142, v142
  v_exp_f32 v143, v143
  v_add_f32 v136, 1.0, v136
  v_add_f32 v137, 1.0, v137
  v_add_f32 v138, 1.0, v138
  v_add_f32 v139, 1.0, v139
  ds_read_b64_tr_b16 v[48:49], v243 offset:49152
  ds_read_b64_tr_b16 v[50:51], v243 offset:50176
  s_waitcnt lgkmcnt(10)
  v_mfma_f32_32x32x16_bf16 v[96:111], v[28:31], v[228:231], v[96:111]
  v_add_f32 v140, 1.0, v140
  v_add_f32 v141, 1.0, v141
  v_add_f32 v142, 1.0, v142
  v_add_f32 v143, 1.0, v143
  v_rcp_f32 v136, v136
  v_rcp_f32 v137, v137
  v_rcp_f32 v138, v138
  v_rcp_f32 v139, v139
  ds_read_b64_tr_b16 v[52:53], v243 offset:53248
  ds_read_b64_tr_b16 v[54:55], v243 offset:54272
  s_waitcnt lgkmcnt(10)
  v_mfma_f32_32x32x16_bf16 v[96:111], v[32:35], v[232:235], v[96:111]
  v_rcp_f32 v140, v140
  v_rcp_f32 v141, v141
  v_rcp_f32 v142, v142
  v_rcp_f32 v143, v143
  v_mul_f32 v136, v136, v88
  v_mul_f32 v137, v137, v89
  v_mul_f32 v138, v138, v90
  v_mul_f32 v139, v139, v91
  ds_read_b64_tr_b16 v[24:25], v243 offset:57344
  ds_read_b64_tr_b16 v[26:27], v243 offset:58368
  s_waitcnt lgkmcnt(10)
  v_mfma_f32_32x32x16_bf16 v[96:111], v[36:39], v[236:239], v[96:111]
  v_mul_f32 v140, v140, v92
  v_mul_f32 v141, v141, v93
  v_mul_f32 v142, v142, v94
  v_mul_f32 v143, v143, v95
  v_cvt_pk_bf16_f32 v156, v136, v137
  v_cvt_pk_bf16_f32 v157, v138, v139
  v_cvt_pk_bf16_f32 v158, v140, v141
  v_cvt_pk_bf16_f32 v159, v142, v143
  ds_read_b64_tr_b16 v[28:29], v243 offset:61440
  ds_read_b64_tr_b16 v[30:31], v243 offset:62464
  s_waitcnt lgkmcnt(10)
  v_mfma_f32_32x32x16_bf16 v[112:127], v[40:43], v[192:195], v[112:127]
  ds_read_b64_tr_b16 v[32:33], v247 offset:40960
  ds_read_b64_tr_b16 v[34:35], v247 offset:41984
  s_waitcnt lgkmcnt(10)
  v_mfma_f32_32x32x16_bf16 v[112:127], v[44:47], v[196:199], v[112:127]
  v_mul_f32 v128, s83, v96
  v_mul_f32 v129, s83, v97
  v_mul_f32 v130, s83, v98
  v_mul_f32 v131, s83, v99
  v_mul_f32 v132, s83, v100
  v_mul_f32 v133, s83, v101
  v_mul_f32 v134, s83, v102
  v_mul_f32 v135, s83, v103
  ds_read_b64_tr_b16 v[36:37], v247 offset:45056
  ds_read_b64_tr_b16 v[38:39], v247 offset:46080
  s_waitcnt lgkmcnt(10)
  v_mfma_f32_32x32x16_bf16 v[112:127], v[48:51], v[200:203], v[112:127]
  v_exp_f32 v128, v128
  v_exp_f32 v129, v129
  v_exp_f32 v130, v130
  v_exp_f32 v131, v131
  v_exp_f32 v132, v132
  v_exp_f32 v133, v133
  v_exp_f32 v134, v134
  v_exp_f32 v135, v135
  ds_read_b64_tr_b16 v[40:41], v247 offset:49152
  ds_read_b64_tr_b16 v[42:43], v247 offset:50176
  s_waitcnt lgkmcnt(10)
  v_mfma_f32_32x32x16_bf16 v[112:127], v[52:55], v[204:207], v[112:127]
  v_add_f32 v128, 1.0, v128
  v_add_f32 v129, 1.0, v129
  v_add_f32 v130, 1.0, v130
  v_add_f32 v131, 1.0, v131
  v_add_f32 v132, 1.0, v132
  v_add_f32 v133, 1.0, v133
  v_add_f32 v134, 1.0, v134
  v_add_f32 v135, 1.0, v135
  ds_read_b64_tr_b16 v[44:45], v247 offset:0
  ds_read_b64_tr_b16 v[46:47], v247 offset:1024
  s_waitcnt lgkmcnt(10)
  v_mfma_f32_32x32x16_bf16 v[112:127], v[24:27], v[208:211], v[112:127]
  v_rcp_f32 v128, v128
  v_rcp_f32 v129, v129
  v_rcp_f32 v130, v130
  v_rcp_f32 v131, v131
  v_rcp_f32 v132, v132
  v_rcp_f32 v133, v133
  v_rcp_f32 v134, v134
  v_rcp_f32 v135, v135
  ds_read_b64_tr_b16 v[48:49], v247 offset:4096
  ds_read_b64_tr_b16 v[50:51], v247 offset:5120
  s_waitcnt lgkmcnt(10)
  v_mfma_f32_32x32x16_bf16 v[112:127], v[28:31], v[212:215], v[112:127]
  v_mul_f32 v128, v128, v96
  v_mul_f32 v129, v129, v97
  v_mul_f32 v130, v130, v98
  v_mul_f32 v131, v131, v99
  v_mul_f32 v132, v132, v100
  v_mul_f32 v133, v133, v101
  v_mul_f32 v134, v134, v102
  v_mul_f32 v135, v135, v103
  ds_read_b64_tr_b16 v[52:53], v247 offset:8192
  ds_read_b64_tr_b16 v[54:55], v247 offset:9216
  s_waitcnt lgkmcnt(10)
  v_mfma_f32_32x32x16_bf16 v[112:127], v[32:35], v[216:219], v[112:127]
  v_cvt_pk_bf16_f32 v160, v128, v129
  v_cvt_pk_bf16_f32 v161, v130, v131
  v_cvt_pk_bf16_f32 v162, v132, v133
  v_cvt_pk_bf16_f32 v163, v134, v135
  v_mul_f32 v136, s83, v104
  v_mul_f32 v137, s83, v105
  v_mul_f32 v138, s83, v106
  v_mul_f32 v139, s83, v107
  s_waitcnt lgkmcnt(8)
  v_mfma_f32_32x32x16_bf16 v[112:127], v[36:39], v[220:223], v[112:127]
  v_mul_f32 v140, s83, v108
  v_mul_f32 v141, s83, v109
  v_mul_f32 v142, s83, v110
  v_mul_f32 v143, s83, v111
  v_exp_f32 v136, v136
  v_exp_f32 v137, v137
  v_exp_f32 v138, v138
  v_exp_f32 v139, v139
  s_waitcnt lgkmcnt(6)
  v_mfma_f32_32x32x16_bf16 v[112:127], v[40:43], v[224:227], v[112:127]
  v_exp_f32 v140, v140
  v_exp_f32 v141, v141
  v_exp_f32 v142, v142
  v_exp_f32 v143, v143
  v_add_f32 v136, 1.0, v136
  v_add_f32 v137, 1.0, v137
  v_add_f32 v138, 1.0, v138
  v_add_f32 v139, 1.0, v139
  s_waitcnt lgkmcnt(4)
  v_mfma_f32_32x32x16_bf16 v[112:127], v[44:47], v[228:231], v[112:127]
  v_add_f32 v140, 1.0, v140
  v_add_f32 v141, 1.0, v141
  v_add_f32 v142, 1.0, v142
  v_add_f32 v143, 1.0, v143
  v_rcp_f32 v136, v136
  v_rcp_f32 v137, v137
  v_rcp_f32 v138, v138
  v_rcp_f32 v139, v139
  s_waitcnt lgkmcnt(2)
  v_mfma_f32_32x32x16_bf16 v[112:127], v[48:51], v[232:235], v[112:127]
  v_rcp_f32 v140, v140
  v_rcp_f32 v141, v141
  v_rcp_f32 v142, v142
  v_rcp_f32 v143, v143
  v_mul_f32 v136, v136, v104
  v_mul_f32 v137, v137, v105
  v_mul_f32 v138, v138, v106
  v_mul_f32 v139, v139, v107
  s_waitcnt lgkmcnt(0)
  v_mfma_f32_32x32x16_bf16 v[112:127], v[52:55], v[236:239], v[112:127]
  v_mul_f32 v140, v140, v108
  v_mul_f32 v141, v141, v109
  v_mul_f32 v142, v142, v110
  v_mul_f32 v143, v143, v111
  v_cvt_pk_bf16_f32 v164, v136, v137
  v_cvt_pk_bf16_f32 v165, v138, v139
  v_cvt_pk_bf16_f32 v166, v140, v141
  v_cvt_pk_bf16_f32 v167, v142, v143
  v_mov_b32 v12, 159744
  v_mov_b32 v13, 1
  s_mov_b64 exec, 1
  ds_add_u32 v12, v13
  s_mov_b64 exec, -1
  s_lshl_b32 s69, s4, 2
  s_add_u32 s69, s69, s10
  s_lshl_b32 s69, s69, 1
  v_lshrrev_b32 v12, 3, v1
  v_mul_u32_u24 v12, 896, v12
  v_bfe_u32 v13, v1, 4, 1
  v_lshlrev_b32 v13, 2, v13
  v_and_b32 v14, 7, v1
  v_xor_b32 v13, v13, v14
  v_lshl_add_u32 v12, v13, 4, v12
  s_lshl_b32 s12, s11, 7
  v_add_u32 v24, s12, v12
  v_add_u32 v25, 7168, v24
  s_mul_i32 s12, s64, 401408
  v_add_u32 v37, s12, v24
  v_add_u32 v38, 7168, v37
  s_lshl_b32 s12, s11, 2
  s_mul_i32 s13, s10, 7
  s_add_u32 s12, s12, s13
  s_sub_u32 s13, s12, 28
  s_cmp_ge_u32 s12, 28
  s_cselect_b32 s12, s13, s12
  s_mul_i32 s70, s12, 14336
  s_lshl_b32 s71, s12, 10
  s_lshl_b32 s12, s69, 8
  s_add_u32 s12, s12, 393216
  v_lshl_add_u32 v39, v2, 3, s12
  buffer_load_dwordx2 v[32:33], v39, s[44:47], 0 offen sc1
  buffer_load_dwordx2 v[34:35], v39, s[44:47], 0 offen offset:256 sc1
  v_mul_f32 v128, s83, v112
  v_mul_f32 v129, s83, v113
  v_mul_f32 v130, s83, v114
  v_mul_f32 v131, s83, v115
  v_mul_f32 v132, s83, v116
  v_mul_f32 v133, s83, v117
  v_mul_f32 v134, s83, v118
  v_mul_f32 v135, s83, v119
  v_exp_f32 v128, v128
  v_exp_f32 v129, v129
  v_exp_f32 v130, v130
  v_exp_f32 v131, v131
  v_exp_f32 v132, v132
  v_exp_f32 v133, v133
  v_exp_f32 v134, v134
  v_exp_f32 v135, v135
  v_add_f32 v128, 1.0, v128
  v_add_f32 v129, 1.0, v129
  v_add_f32 v130, 1.0, v130
  v_add_f32 v131, 1.0, v131
  v_add_f32 v132, 1.0, v132
  v_add_f32 v133, 1.0, v133
  v_add_f32 v134, 1.0, v134
  v_add_f32 v135, 1.0, v135
  v_rcp_f32 v128, v128
  v_rcp_f32 v129, v129
  v_rcp_f32 v130, v130
  v_rcp_f32 v131, v131
  v_rcp_f32 v132, v132
  v_rcp_f32 v133, v133
  v_rcp_f32 v134, v134
  v_rcp_f32 v135, v135
  v_mul_f32 v128, v128, v112
  v_mul_f32 v129, v129, v113
  v_mul_f32 v130, v130, v114
  v_mul_f32 v131, v131, v115
  v_mul_f32 v132, v132, v116
  v_mul_f32 v133, v133, v117
  v_mul_f32 v134, v134, v118
  v_mul_f32 v135, v135, v119
  v_cvt_pk_bf16_f32 v168, v128, v129
  v_cvt_pk_bf16_f32 v169, v130, v131
  v_cvt_pk_bf16_f32 v170, v132, v133
  v_cvt_pk_bf16_f32 v171, v134, v135
  v_mul_f32 v136, s83, v120
  v_mul_f32 v137, s83, v121
  v_mul_f32 v138, s83, v122
  v_mul_f32 v139, s83, v123
  v_mul_f32 v140, s83, v124
  v_mul_f32 v141, s83, v125
  v_mul_f32 v142, s83, v126
  v_mul_f32 v143, s83, v127
  v_exp_f32 v136, v136
  v_exp_f32 v137, v137
  v_exp_f32 v138, v138
  v_exp_f32 v139, v139
  v_exp_f32 v140, v140
  v_exp_f32 v141, v141
  v_exp_f32 v142, v142
  v_exp_f32 v143, v143
  v_add_f32 v136, 1.0, v136
  v_add_f32 v137, 1.0, v137
  v_add_f32 v138, 1.0, v138
  v_add_f32 v139, 1.0, v139
  v_add_f32 v140, 1.0, v140
  v_add_f32 v141, 1.0, v141
  v_add_f32 v142, 1.0, v142
  v_add_f32 v143, 1.0, v143
  v_rcp_f32 v136, v136
  v_rcp_f32 v137, v137
  v_rcp_f32 v138, v138
  v_rcp_f32 v139, v139
  v_rcp_f32 v140, v140
  v_rcp_f32 v141, v141
  v_rcp_f32 v142, v142
  v_rcp_f32 v143, v143
  v_mul_f32 v136, v136, v120
  v_mul_f32 v137, v137, v121
  v_mul_f32 v138, v138, v122
  v_mul_f32 v139, v139, v123
  v_mul_f32 v140, v140, v124
  v_mul_f32 v141, v141, v125
  v_mul_f32 v142, v142, v126
  v_mul_f32 v143, v143, v127
  v_cvt_pk_bf16_f32 v172, v136, v137
  v_cvt_pk_bf16_f32 v173, v138, v139
  v_cvt_pk_bf16_f32 v174, v140, v141
  v_cvt_pk_bf16_f32 v175, v142, v143
  v_mov_b32 v12, 159788
  s_mov_b32 s12, 1000000
L_lw_17:
  ds_read_b32 v13, v12
  s_waitcnt lgkmcnt(0)
  v_readfirstlane_b32 s13, v13
  s_nop 0
  s_cmp_ge_u32 s13, 4
  s_cbranch_scc1 L_lwd_18
  s_sleep 1
  s_sub_u32 s12, s12, 1
  s_cmp_lg_u32 s12, 0
  s_cbranch_scc1 L_lw_17
L_lwd_18:
  s_lshl_b32 s13, s6, 2
  s_add_u32 s13, s13, s64
  s_mul_i32 s13, s13, 144
  s_lshl_b32 s14, s7, 3
  s_add_u32 s13, s13, s14
  s_lshl_b32 s13, s13, 10
  s_add_u32 s13, s13, 8388608
  s_add_u32 s15, s13, 4096
  buffer_store_dwordx4 v[144:147], v4, s[44:47], s13 offen offset:0 sc1
  buffer_store_dwordx4 v[148:151], v4, s[44:47], s13 offen offset:1024 sc1
  buffer_store_dwordx4 v[152:155], v4, s[44:47], s13 offen offset:2048 sc1
  buffer_store_dwordx4 v[156:159], v4, s[44:47], s13 offen offset:3072 sc1
  buffer_store_dwordx4 v[160:163], v4, s[44:47], s15 offen offset:0 sc1
  buffer_store_dwordx4 v[164:167], v4, s[44:47], s15 offen offset:1024 sc1
  buffer_store_dwordx4 v[168:171], v4, s[44:47], s15 offen offset:2048 sc1
  buffer_store_dwordx4 v[172:175], v4, s[44:47], s15 offen offset:3072 sc1
  s_lshl_b32 s12, s6, 2
  s_add_u32 s12, s12, s64
  s_lshl_b32 s12, s12, 4
  s_add_u32 s12, s12, s7
  s_lshl_b32 s12, s12, 7
  s_add_u32 s14, s12, 131072
  s_waitcnt vmcnt(0)
  v_mov_b32 v12, s14
  v_mov_b32 v13, s8
  s_mov_b64 exec, 1
  buffer_store_dword v13, v12, s[44:47], 0 offen sc1
  s_mov_b64 exec, -1
  s_setprio 2
  v_mov_b32 v12, 159764
  s_mov_b32 s12, 1000000
L_lw_19:
  ds_read_b32 v13, v12
  s_waitcnt lgkmcnt(0)
  v_readfirstlane_b32 s13, v13
  s_nop 0
  s_cmp_ge_u32 s13, 8
  s_cbranch_scc1 L_lwd_20
  s_sleep 1
  s_sub_u32 s12, s12, 1
  s_cmp_lg_u32 s12, 0
  s_cbranch_scc1 L_lw_19
L_lwd_20:
  v_mov_b32 v12, 159744
  s_mov_b32 s12, 1000000
L_lw_21:
  ds_read_b32 v13, v12
  s_waitcnt lgkmcnt(0)
  v_readfirstlane_b32 s13, v13
  s_nop 0
  s_cmp_ge_u32 s13, 4
  s_cbranch_scc1 L_lwd_22
  s_sleep 1
  s_sub_u32 s12, s12, 1
  s_cmp_lg_u32 s12, 0
  s_cbranch_scc1 L_lw_21
L_lwd_22:
  s_add_u32 m0, s68, 0
  s_nop 0
  buffer_load_dwordx4 v37, s[32:35], s70 offen lds
  s_add_u32 m0, s68, 1024
  s_nop 0
  buffer_load_dwordx4 v38, s[32:35], s70 offen lds
  s_add_u32 s70, s70, 14336
  s_cmp_ge_u32 s70, 401408
  s_cselect_b32 s70, 0, s70
  s_waitcnt vmcnt(4)
  s_add_u32 m0, s68, 2048
  s_nop 0
  buffer_load_dwordx4 v37, s[32:35], s70 offen lds
  s_add_u32 m0, s68, 3072
  s_nop 0
  buffer_load_dwordx4 v38, s[32:35], s70 offen lds
  s_add_u32 s70, s70, 14336
  s_cmp_ge_u32 s70, 401408
  s_cselect_b32 s70, 0, s70
  s_waitcnt vmcnt(4)
  s_add_u32 m0, s68, 4096
  s_nop 0
  buffer_load_dwordx4 v37, s[32:35], s70 offen lds
  s_add_u32 m0, s68, 5120
  s_nop 0
  buffer_load_dwordx4 v38, s[32:35], s70 offen lds
  s_add_u32 s70, s70, 14336
  s_cmp_ge_u32 s70, 401408
  s_cselect_b32 s70, 0, s70
  s_waitcnt vmcnt(4)
  s_add_u32 m0, s68, 6144
  s_nop 0
  buffer_load_dwordx4 v37, s[32:35], s70 offen lds
  s_add_u32 m0, s68, 7168
  s_nop 0
  buffer_load_dwordx4 v38, s[32:35], s70 offen lds
  s_add_u32 s70, s70, 14336
  s_cmp_ge_u32 s70, 401408
  s_cselect_b32 s70, 0, s70
  s_waitcnt vmcnt(4)
  s_add_u32 m0, s68, 8192
  s_nop 0
  buffer_load_dwordx4 v37, s[32:35], s70 offen lds
  s_add_u32 m0, s68, 9216
  s_nop 0
  buffer_load_dwordx4 v38, s[32:35], s70 offen lds
  s_add_u32 s70, s70, 14336
  s_cmp_ge_u32 s70, 401408
  s_cselect_b32 s70, 0, s70
  s_waitcnt vmcnt(4)
  s_add_u32 m0, s68, 10240
  s_nop 0
  buffer_load_dwordx4 v37, s[32:35], s70 offen lds
  s_add_u32 m0, s68, 11264
  s_nop 0
  buffer_load_dwordx4 v38, s[32:35], s70 offen lds
  s_add_u32 s70, s70, 14336
  s_cmp_ge_u32 s70, 401408
  s_cselect_b32 s70, 0, s70
  s_waitcnt vmcnt(4)
  s_add_u32 m0, s68, 12288
  s_nop 0
  buffer_load_dwordx4 v37, s[32:35], s70 offen lds
  s_add_u32 m0, s68, 13312
  s_nop 0
  buffer_load_dwordx4 v38, s[32:35], s70 offen lds
  s_add_u32 s70, s70, 14336
  s_cmp_ge_u32 s70, 401408
  s_cselect_b32 s70, 0, s70
  s_waitcnt vmcnt(4)
  s_add_u32 m0, s68, 14336
  s_nop 0
  buffer_load_dwordx4 v37, s[32:35], s70 offen lds
  s_add_u32 m0, s68, 15360
  s_nop 0
  buffer_load_dwordx4 v38, s[32:35], s70 offen lds
  s_add_u32 s70, s70, 14336
  s_cmp_ge_u32 s70, 401408
  s_cselect_b32 s70, 0, s70
  s_waitcnt vmcnt(4)
  s_add_u32 m0, s68, 16384
  s_nop 0
  buffer_load_dwordx4 v37, s[32:35], s70 offen lds
  s_add_u32 m0, s68, 17408
  s_nop 0
  buffer_load_dwordx4 v38, s[32:35], s70 offen lds
  s_add_u32 s70, s70, 14336
  s_cmp_ge_u32 s70, 401408
  s_cselect_b32 s70, 0, s70
  s_waitcnt vmcnt(4)
  s_add_u32 m0, s68, 18432
  s_nop 0
  buffer_load_dwordx4 v37, s[32:35], s70 offen lds
  s_add_u32 m0, s68, 19456
  s_nop 0
  buffer_load_dwordx4 v38, s[32:35], s70 offen lds
  s_add_u32 s70, s70, 14336
  s_cmp_ge_u32 s70, 401408
  s_cselect_b32 s70, 0, s70
  s_waitcnt vmcnt(4)
  s_add_u32 m0, s68, 20480
  s_nop 0
  buffer_load_dwordx4 v37, s[32:35], s70 offen lds
  s_add_u32 m0, s68, 21504
  s_nop 0
  buffer_load_dwordx4 v38, s[32:35], s70 offen lds
  s_add_u32 s70, s70, 14336
  s_cmp_ge_u32 s70, 401408
  s_cselect_b32 s70, 0, s70
  s_waitcnt vmcnt(4)
  s_add_u32 m0, s68, 22528
  s_nop 0
  buffer_load_dwordx4 v37, s[32:35], s70 offen lds
  s_add_u32 m0, s68, 23552
  s_nop 0
  buffer_load_dwordx4 v38, s[32:35], s70 offen lds
  s_add_u32 s70, s70, 14336
  s_cmp_ge_u32 s70, 401408
  s_cselect_b32 s70, 0, s70
  s_waitcnt vmcnt(4)
  s_cmp_lg_u32 s3, 7
  s_cbranch_scc1 L_noarr
  v_mov_b32 v8, 0
  v_mov_b32 v9, 1
  s_mov_b64 exec, 1
  buffer_atomic_add v9, v8, s[48:51], 0 offen sc0
  s_waitcnt vmcnt(0)
  s_mov_b64 exec, -1
  v_readfirstlane_b32 s12, v9
  s_nop 0
  s_cmp_lg_u32 s12, 255
  s_cbranch_scc1 L_ep_23
  s_add_u32 s12, s9, 1
  v_mov_b32 v9, s12
  s_mov_b64 exec, 1
  buffer_store_dword v9, v8, s[44:47], 0 offen sc1
  s_mov_b64 exec, -1
L_ep_23:
L_noarr:
  v_and_b32 v12, 3, v1
  v_bfe_u32 v13, v1, 2, 1
  v_lshl_add_u32 v12, v13, 4, v12
  s_mul_i32 s12, s64, 28
  s_lshr_b32 s12, s12, 3
  s_lshl_b32 s13, s69, 4
  s_add_u32 s12, s12, s13
  v_add_u32 v12, s12, v12
  v_lshlrev_b32 v12, 7, v12
  v_add_u32 v12, 131072, v12
  s_mul_i32 s12, s69, 147456
  s_mul_i32 s13, s64, 28672
  s_add_u32 s12, s12, s13
  s_add_u32 s12, s12, 8388608
  v_add_u32 v26, s12, v4
  v_add_u32 v27, 147456, v26
  s_bitcmp1_b32 s64, 1
  s_cbranch_scc0 L_nosw1
  v_swap_b32 v26, v27
L_nosw1:
  v_bfe_u32 v13, v1, 2, 2
  v_lshl_add_u32 v14, v3, 2, v13
  v_lshlrev_b32 v14, 7, v14
  v_lshrrev_b32 v13, 1, v13
  v_lshl_add_u32 v14, v13, 6, v14
  v_bfe_u32 v13, v1, 4, 1
  v_lshl_add_u32 v14, v13, 5, v14
  v_and_b32 v13, 3, v1
  v_lshl_add_u32 v14, v13, 3, v14
  v_add_u32 v20, s68, v14
  s_and_b32 s12, s64, 1
  s_lshl_b32 s12, s12, 6
  v_xor_b32 v20, s12, v20
  v_xor_b32 v21, 64, v20
  v_xor_b32 v13, s8, v33
  v_xor_b32 v14, s8, v35
  v_or_b32 v13, v13, v14
  v_cmp_ne_u32 vcc, 0, v13
  s_nop 0
  s_cbranch_vccz L_fg_ok
  s_lshl_b32 s12, s69, 8
  s_add_u32 s12, s12, 393216
  v_lshl_add_u32 v13, v2, 3, s12
  s_mov_b32 s13, 100000
L_gl_24:
  buffer_load_dwordx2 v[32:33], v13, s[44:47], 0 offen sc1
  s_waitcnt vmcnt(0)
  v_cmp_ne_u32 vcc, s8, v33
  s_nop 0
  s_cbranch_vccz L_gld_25
  s_sleep 1
  s_sub_u32 s13, s13, 1
  s_cmp_lg_u32 s13, 0
  s_cbranch_scc1 L_gl_24
L_gld_25:
  s_add_u32 s72, s69, 1
  s_lshl_b32 s12, s72, 8
  s_add_u32 s12, s12, 393216
  v_lshl_add_u32 v13, v2, 3, s12
  s_mov_b32 s13, 100000
L_gl_26:
  buffer_load_dwordx2 v[34:35], v13, s[44:47], 0 offen sc1
  s_waitcnt vmcnt(0)
  v_cmp_ne_u32 vcc, s8, v35
  s_nop 0
  s_cbranch_vccz L_gld_27
  s_sleep 1
  s_sub_u32 s13, s13, 1
  s_cmp_lg_u32 s13, 0
  s_cbranch_scc1 L_gl_26
L_gld_27:
L_fg_ok:
  s_bitcmp1_b32 s64, 1
  s_cbranch_scc0 L_nosw2
  v_swap_b32 v32, v34
L_nosw2:
  s_mov_b32 s12, 100000
  buffer_load_dword v56, v12, s[44:47], 0 offen sc1
  s_sleep 6
L_poll_28:
  buffer_load_dword v57, v12, s[44:47], 0 offen sc1
  s_waitcnt vmcnt(1)
  v_xor_b32 v56, s8, v56
  v_cmp_ne_u32 vcc, 0, v56
  s_nop 0
  s_cbranch_vccz L_polld_29
  s_sleep 6
  buffer_load_dword v56, v12, s[44:47], 0 offen sc1
  s_waitcnt vmcnt(1)
  v_xor_b32 v57, s8, v57
  v_cmp_ne_u32 vcc, 0, v57
  s_nop 0
  s_cbranch_vccz L_polld_29
  s_sleep 6
  s_sub_u32 s12, s12, 1
  s_cmp_lg_u32 s12, 0
  s_cbranch_scc1 L_poll_28
L_polld_29:
  buffer_load_dwordx4 v[128:131], v26, s[44:47], s71 offen sc1
  buffer_load_dwordx4 v[132:135], v27, s[44:47], s71 offen sc1
  s_add_u32 s71, s71, 1024
  s_cmp_ge_u32 s71, 28672
  s_cselect_b32 s71, 0, s71
  s_waitcnt vmcnt(2)
  buffer_load_dwordx4 v[136:139], v26, s[44:47], s71 offen sc1
  buffer_load_dwordx4 v[140:143], v27, s[44:47], s71 offen sc1
  s_add_u32 s71, s71, 1024
  s_cmp_ge_u32 s71, 28672
  s_cselect_b32 s71, 0, s71
  s_waitcnt vmcnt(2)
  buffer_load_dwordx4 v[144:147], v26, s[44:47], s71 offen sc1
  buffer_load_dwordx4 v[148:151], v27, s[44:47], s71 offen sc1
  s_add_u32 s71, s71, 1024
  s_cmp_ge_u32 s71, 28672
  s_cselect_b32 s71, 0, s71
  s_waitcnt vmcnt(2)
  buffer_load_dwordx4 v[152:155], v26, s[44:47], s71 offen sc1
  buffer_load_dwordx4 v[156:159], v27, s[44:47], s71 offen sc1
  s_add_u32 s71, s71, 1024
  s_cmp_ge_u32 s71, 28672
  s_cselect_b32 s71, 0, s71
  s_waitcnt vmcnt(2)
  buffer_load_dwordx4 v[160:163], v26, s[44:47], s71 offen sc1
  buffer_load_dwordx4 v[164:167], v27, s[44:47], s71 offen sc1
  s_add_u32 s71, s71, 1024
  s_cmp_ge_u32 s71, 28672
  s_cselect_b32 s71, 0, s71
  s_waitcnt vmcnt(2)
  buffer_load_dwordx4 v[168:171], v26, s[44:47], s71 offen sc1
  buffer_load_dwordx4 v[172:175], v27, s[44:47], s71 offen sc1
  s_add_u32 s71, s71, 1024
  s_cmp_ge_u32 s71, 28672
  s_cselect_b32 s71, 0, s71
  s_waitcnt vmcnt(2)
  buffer_load_dwordx4 v[176:179], v26, s[44:47], s71 offen sc1
  buffer_load_dwordx4 v[180:183], v27, s[44:47], s71 offen sc1
  s_add_u32 s71, s71, 1024
  s_cmp_ge_u32 s71, 28672
  s_cselect_b32 s71, 0, s71
  s_waitcnt vmcnt(2)
  buffer_load_dwordx4 v[184:187], v26, s[44:47], s71 offen sc1
  buffer_load_dwordx4 v[188:191], v27, s[44:47], s71 offen sc1
  s_add_u32 s71, s71, 1024
  s_cmp_ge_u32 s71, 28672
  s_cselect_b32 s71, 0, s71
  s_waitcnt vmcnt(2)
  buffer_load_dwordx4 v[192:195], v26, s[44:47], s71 offen sc1
  buffer_load_dwordx4 v[196:199], v27, s[44:47], s71 offen sc1
  s_add_u32 s71, s71, 1024
  s_cmp_ge_u32 s71, 28672
  s_cselect_b32 s71, 0, s71
  s_waitcnt vmcnt(2)
  buffer_load_dwordx4 v[200:203], v26, s[44:47], s71 offen sc1
  buffer_load_dwordx4 v[204:207], v27, s[44:47], s71 offen sc1
  s_add_u32 s71, s71, 1024
  s_cmp_ge_u32 s71, 28672
  s_cselect_b32 s71, 0, s71
  s_waitcnt vmcnt(2)
  buffer_load_dwordx4 v[208:211], v26, s[44:47], s71 offen sc1
  buffer_load_dwordx4 v[212:215], v27, s[44:47], s71 offen sc1
  s_add_u32 s71, s71, 1024
  s_cmp_ge_u32 s71, 28672
  s_cselect_b32 s71, 0, s71
  s_waitcnt vmcnt(2)
  buffer_load_dwordx4 v[216:219], v26, s[44:47], s71 offen sc1
  buffer_load_dwordx4 v[220:223], v27, s[44:47], s71 offen sc1
  s_add_u32 s71, s71, 1024
  s_cmp_ge_u32 s71, 28672
  s_cselect_b32 s71, 0, s71
  s_waitcnt vmcnt(2)
  ds_read_b64_tr_b16 v[224:225], v20 offset:0
  ds_read_b64_tr_b16 v[226:227], v20 offset:1024
  ds_read_b64_tr_b16 v[228:229], v21 offset:0
  ds_read_b64_tr_b16 v[230:231], v21 offset:1024
  s_waitcnt vmcnt(4)
  ds_read_b64_tr_b16 v[232:233], v20 offset:2048
  ds_read_b64_tr_b16 v[234:235], v20 offset:3072
  ds_read_b64_tr_b16 v[236:237], v21 offset:2048
  ds_read_b64_tr_b16 v[238:239], v21 offset:3072
  s_waitcnt lgkmcnt(4)
  v_mfma_f32_32x32x16_bf16 v[64:79], v[224:227], v[128:131], 0
  v_mfma_f32_32x32x16_bf16 v[80:95], v[228:231], v[128:131], 0
  v_mfma_f32_32x32x16_bf16 v[96:111], v[224:227], v[132:135], 0
  v_mfma_f32_32x32x16_bf16 v[112:127], v[228:231], v[132:135], 0
  s_add_u32 m0, s68, 0
  s_nop 0
  buffer_load_dwordx4 v37, s[32:35], s70 offen lds
  s_add_u32 m0, s68, 1024
  s_nop 0
  buffer_load_dwordx4 v38, s[32:35], s70 offen lds
  s_add_u32 s70, s70, 14336
  s_cmp_ge_u32 s70, 401408
  s_cselect_b32 s70, 0, s70
  buffer_load_dwordx4 v[128:131], v26, s[44:47], s71 offen sc1
  buffer_load_dwordx4 v[132:135], v27, s[44:47], s71 offen sc1
  s_add_u32 s71, s71, 1024
  s_cmp_ge_u32 s71, 28672
  s_cselect_b32 s71, 0, s71
  s_waitcnt vmcnt(4)
  ds_read_b64_tr_b16 v[224:225], v20 offset:4096
  ds_read_b64_tr_b16 v[226:227], v20 offset:5120
  ds_read_b64_tr_b16 v[228:229], v21 offset:4096
  ds_read_b64_tr_b16 v[230:231], v21 offset:5120
  s_waitcnt lgkmcnt(4)
  v_mfma_f32_32x32x16_bf16 v[64:79], v[232:235], v[136:139], v[64:79]
  v_mfma_f32_32x32x16_bf16 v[80:95], v[236:239], v[136:139], v[80:95]
  v_mfma_f32_32x32x16_bf16 v[96:111], v[232:235], v[140:143], v[96:111]
  v_mfma_f32_32x32x16_bf16 v[112:127], v[236:239], v[140:143], v[112:127]
  s_add_u32 m0, s68, 2048
  s_nop 0
  buffer_load_dwordx4 v37, s[32:35], s70 offen lds
  s_add_u32 m0, s68, 3072
  s_nop 0
  buffer_load_dwordx4 v38, s[32:35], s70 offen lds
  s_add_u32 s70, s70, 14336
  s_cmp_ge_u32 s70, 401408
  s_cselect_b32 s70, 0, s70
  buffer_load_dwordx4 v[136:139], v26, s[44:47], s71 offen sc1
  buffer_load_dwordx4 v[140:143], v27, s[44:47], s71 offen sc1
  s_add_u32 s71, s71, 1024
  s_cmp_ge_u32 s71, 28672
  s_cselect_b32 s71, 0, s71
  s_waitcnt vmcnt(4)
  ds_read_b64_tr_b16 v[232:233], v20 offset:6144
  ds_read_b64_tr_b16 v[234:235], v20 offset:7168
  ds_read_b64_tr_b16 v[236:237], v21 offset:6144
  ds_read_b64_tr_b16 v[238:239], v21 offset:7168
  s_waitcnt lgkmcnt(4)
  v_mfma_f32_32x32x16_bf16 v[64:79], v[224:227], v[144:147], v[64:79]
  v_mfma_f32_32x32x16_bf16 v[80:95], v[228:231], v[144:147], v[80:95]
  v_mfma_f32_32x32x16_bf16 v[96:111], v[224:227], v[148:151], v[96:111]
  v_mfma_f32_32x32x16_bf16 v[112:127], v[228:231], v[148:151], v[112:127]
  s_add_u32 m0, s68, 4096
  s_nop 0
  buffer_load_dwordx4 v37, s[32:35], s70 offen lds
  s_add_u32 m0, s68, 5120
  s_nop 0
  buffer_load_dwordx4 v38, s[32:35], s70 offen lds
  s_add_u32 s70, s70, 14336
  s_cmp_ge_u32 s70, 401408
  s_cselect_b32 s70, 0, s70
  buffer_load_dwordx4 v[144:147], v26, s[44:47], s71 offen sc1
  buffer_load_dwordx4 v[148:151], v27, s[44:47], s71 offen sc1
  s_add_u32 s71, s71, 1024
  s_cmp_ge_u32 s71, 28672
  s_cselect_b32 s71, 0, s71
  s_waitcnt vmcnt(4)
  ds_read_b64_tr_b16 v[224:225], v20 offset:8192
  ds_read_b64_tr_b16 v[226:227], v20 offset:9216
  ds_read_b64_tr_b16 v[228:229], v21 offset:8192
  ds_read_b64_tr_b16 v[230:231], v21 offset:9216
  s_waitcnt lgkmcnt(4)
  v_mfma_f32_32x32x16_bf16 v[64:79], v[232:235], v[152:155], v[64:79]
  v_mfma_f32_32x32x16_bf16 v[80:95], v[236:239], v[152:155], v[80:95]
  v_mfma_f32_32x32x16_bf16 v[96:111], v[232:235], v[156:159], v[96:111]
  v_mfma_f32_32x32x16_bf16 v[112:127], v[236:239], v[156:159], v[112:127]
  s_add_u32 m0, s68, 6144
  s_nop 0
  buffer_load_dwordx4 v37, s[32:35], s70 offen lds
  s_add_u32 m0, s68, 7168
  s_nop 0
  buffer_load_dwordx4 v38, s[32:35], s70 offen lds
  s_add_u32 s70, s70, 14336
  s_cmp_ge_u32 s70, 401408
  s_cselect_b32 s70, 0, s70
  buffer_load_dwordx4 v[152:155], v26, s[44:47], s71 offen sc1
  buffer_load_dwordx4 v[156:159], v27, s[44:47], s71 offen sc1
  s_add_u32 s71, s71, 1024
  s_cmp_ge_u32 s71, 28672
  s_cselect_b32 s71, 0, s71
  s_waitcnt vmcnt(4)
  ds_read_b64_tr_b16 v[232:233], v20 offset:10240
  ds_read_b64_tr_b16 v[234:235], v20 offset:11264
  ds_read_b64_tr_b16 v[236:237], v21 offset:10240
  ds_read_b64_tr_b16 v[238:239], v21 offset:11264
  s_waitcnt lgkmcnt(4)
  v_mfma_f32_32x32x16_bf16 v[64:79], v[224:227], v[160:163], v[64:79]
  v_mfma_f32_32x32x16_bf16 v[80:95], v[228:231], v[160:163], v[80:95]
  v_mfma_f32_32x32x16_bf16 v[96:111], v[224:227], v[164:167], v[96:111]
  v_mfma_f32_32x32x16_bf16 v[112:127], v[228:231], v[164:167], v[112:127]
  s_add_u32 m0, s68, 8192
  s_nop 0
  buffer_load_dwordx4 v37, s[32:35], s70 offen lds
  s_add_u32 m0, s68, 9216
  s_nop 0
  buffer_load_dwordx4 v38, s[32:35], s70 offen lds
  s_add_u32 s70, s70, 14336
  s_cmp_ge_u32 s70, 401408
  s_cselect_b32 s70, 0, s70
  buffer_load_dwordx4 v[160:163], v26, s[44:47], s71 offen sc1
  buffer_load_dwordx4 v[164:167], v27, s[44:47], s71 offen sc1
  s_add_u32 s71, s71, 1024
  s_cmp_ge_u32 s71, 28672
  s_cselect_b32 s71, 0, s71
  s_waitcnt vmcnt(4)
  ds_read_b64_tr_b16 v[224:225], v20 offset:12288
  ds_read_b64_tr_b16 v[226:227], v20 offset:13312
  ds_read_b64_tr_b16 v[228:229], v21 offset:12288
  ds_read_b64_tr_b16 v[230:231], v21 offset:13312
  s_waitcnt lgkmcnt(4)
  v_mfma_f32_32x32x16_bf16 v[64:79], v[232:235], v[168:171], v[64:79]
  v_mfma_f32_32x32x16_bf16 v[80:95], v[236:239], v[168:171], v[80:95]
  v_mfma_f32_32x32x16_bf16 v[96:111], v[232:235], v[172:175], v[96:111]
  v_mfma_f32_32x32x16_bf16 v[112:127], v[236:239], v[172:175], v[112:127]
  s_add_u32 m0, s68, 10240
  s_nop 0
  buffer_load_dwordx4 v37, s[32:35], s70 offen lds
  s_add_u32 m0, s68, 11264
  s_nop 0
  buffer_load_dwordx4 v38, s[32:35], s70 offen lds
  s_add_u32 s70, s70, 14336
  s_cmp_ge_u32 s70, 401408
  s_cselect_b32 s70, 0, s70
  buffer_load_dwordx4 v[168:171], v26, s[44:47], s71 offen sc1
  buffer_load_dwordx4 v[172:175], v27, s[44:47], s71 offen sc1
  s_add_u32 s71, s71, 1024
  s_cmp_ge_u32 s71, 28672
  s_cselect_b32 s71, 0, s71
  s_waitcnt vmcnt(4)
  ds_read_b64_tr_b16 v[232:233], v20 offset:14336
  ds_read_b64_tr_b16 v[234:235], v20 offset:15360
  ds_read_b64_tr_b16 v[236:237], v21 offset:14336
  ds_read_b64_tr_b16 v[238:239], v21 offset:15360
  s_waitcnt lgkmcnt(4)
  v_mfma_f32_32x32x16_bf16 v[64:79], v[224:227], v[176:179], v[64:79]
  v_mfma_f32_32x32x16_bf16 v[80:95], v[228:231], v[176:179], v[80:95]
  v_mfma_f32_32x32x16_bf16 v[96:111], v[224:227], v[180:183], v[96:111]
  v_mfma_f32_32x32x16_bf16 v[112:127], v[228:231], v[180:183], v[112:127]
  s_add_u32 m0, s68, 12288
  s_nop 0
  buffer_load_dwordx4 v37, s[32:35], s70 offen lds
  s_add_u32 m0, s68, 13312
  s_nop 0
  buffer_load_dwordx4 v38, s[32:35], s70 offen lds
  s_add_u32 s70, s70, 14336
  s_cmp_ge_u32 s70, 401408
  s_cselect_b32 s70, 0, s70
  buffer_load_dwordx4 v[176:179], v26, s[44:47], s71 offen sc1
  buffer_load_dwordx4 v[180:183], v27, s[44:47], s71 offen sc1
  s_add_u32 s71, s71, 1024
  s_cmp_ge_u32 s71, 28672
  s_cselect_b32 s71, 0, s71
  s_waitcnt vmcnt(4)
  ds_read_b64_tr_b16 v[224:225], v20 offset:16384
  ds_read_b64_tr_b16 v[226:227], v20 offset:17408
  ds_read_b64_tr_b16 v[228:229], v21 offset:16384
  ds_read_b64_tr_b16 v[230:231], v21 offset:17408
  s_waitcnt lgkmcnt(4)
  v_mfma_f32_32x32x16_bf16 v[64:79], v[232:235], v[184:187], v[64:79]
  v_mfma_f32_32x32x16_bf16 v[80:95], v[236:239], v[184:187], v[80:95]
  v_mfma_f32_32x32x16_bf16 v[96:111], v[232:235], v[188:191], v[96:111]
  v_mfma_f32_32x32x16_bf16 v[112:127], v[236:239], v[188:191], v[112:127]
  s_add_u32 m0, s68, 14336
  s_nop 0
  buffer_load_dwordx4 v37, s[32:35], s70 offen lds
  s_add_u32 m0, s68, 15360
  s_nop 0
  buffer_load_dwordx4 v38, s[32:35], s70 offen lds
  s_add_u32 s70, s70, 14336
  s_cmp_ge_u32 s70, 401408
  s_cselect_b32 s70, 0, s70
  buffer_load_dwordx4 v[184:187], v26, s[44:47], s71 offen sc1
  buffer_load_dwordx4 v[188:191], v27, s[44:47], s71 offen sc1
  s_add_u32 s71, s71, 1024
  s_cmp_ge_u32 s71, 28672
  s_cselect_b32 s71, 0, s71
  s_waitcnt vmcnt(4)
  ds_read_b64_tr_b16 v[232:233], v20 offset:18432
  ds_read_b64_tr_b16 v[234:235], v20 offset:19456
  ds_read_b64_tr_b16 v[236:237], v21 offset:18432
  ds_read_b64_tr_b16 v[238:239], v21 offset:19456
  s_waitcnt lgkmcnt(4)
  v_mfma_f32_32x32x16_bf16 v[64:79], v[224:227], v[192:195], v[64:79]
  v_mfma_f32_32x32x16_bf16 v[80:95], v[228:231], v[192:195], v[80:95]
  v_mfma_f32_32x32x16_bf16 v[96:111], v[224:227], v[196:199], v[96:111]
  v_mfma_f32_32x32x16_bf16 v[112:127], v[228:231], v[196:199], v[112:127]
  s_add_u32 m0, s68, 16384
  s_nop 0
  buffer_load_dwordx4 v37, s[32:35], s70 offen lds
  s_add_u32 m0, s68, 17408
  s_nop 0
  buffer_load_dwordx4 v38, s[32:35], s70 offen lds
  s_add_u32 s70, s70, 14336
  s_cmp_ge_u32 s70, 401408
  s_cselect_b32 s70, 0, s70
  buffer_load_dwordx4 v[192:195], v26, s[44:47], s71 offen sc1
  buffer_load_dwordx4 v[196:199], v27, s[44:47], s71 offen sc1
  s_add_u32 s71, s71, 1024
  s_cmp_ge_u32 s71, 28672
  s_cselect_b32 s71, 0, s71
  s_waitcnt vmcnt(4)
  ds_read_b64_tr_b16 v[224:225], v20 offset:20480
  ds_read_b64_tr_b16 v[226:227], v20 offset:21504
  ds_read_b64_tr_b16 v[228:229], v21 offset:20480
  ds_read_b64_tr_b16 v[230:231], v21 offset:21504
  s_waitcnt lgkmcnt(4)
  v_mfma_f32_32x32x16_bf16 v[64:79], v[232:235], v[200:203], v[64:79]
  v_mfma_f32_32x32x16_bf16 v[80:95], v[236:239], v[200:203], v[80:95]
  v_mfma_f32_32x32x16_bf16 v[96:111], v[232:235], v[204:207], v[96:111]
  v_mfma_f32_32x32x16_bf16 v[112:127], v[236:239], v[204:207], v[112:127]
  s_add_u32 m0, s68, 18432
  s_nop 0
  buffer_load_dwordx4 v37, s[32:35], s70 offen lds
  s_add_u32 m0, s68, 19456
  s_nop 0
  buffer_load_dwordx4 v38, s[32:35], s70 offen lds
  s_add_u32 s70, s70, 14336
  s_cmp_ge_u32 s70, 401408
  s_cselect_b32 s70, 0, s70
  buffer_load_dwordx4 v[200:203], v26, s[44:47], s71 offen sc1
  buffer_load_dwordx4 v[204:207], v27, s[44:47], s71 offen sc1
  s_add_u32 s71, s71, 1024
  s_cmp_ge_u32 s71, 28672
  s_cselect_b32 s71, 0, s71
  s_waitcnt vmcnt(4)
  ds_read_b64_tr_b16 v[232:233], v20 offset:22528
  ds_read_b64_tr_b16 v[234:235], v20 offset:23552
  ds_read_b64_tr_b16 v[236:237], v21 offset:22528
  ds_read_b64_tr_b16 v[238:239], v21 offset:23552
  s_waitcnt lgkmcnt(4)
  v_mfma_f32_32x32x16_bf16 v[64:79], v[224:227], v[208:211], v[64:79]
  v_mfma_f32_32x32x16_bf16 v[80:95], v[228:231], v[208:211], v[80:95]
  v_mfma_f32_32x32x16_bf16 v[96:111], v[224:227], v[212:215], v[96:111]
  v_mfma_f32_32x32x16_bf16 v[112:127], v[228:231], v[212:215], v[112:127]
  v_mov_b32 v12, 159792
  s_mov_b32 s12, 1000000
L_lw_30:
  ds_read_b32 v13, v12
  s_waitcnt lgkmcnt(0)
  v_readfirstlane_b32 s13, v13
  s_nop 0
  s_cmp_ge_u32 s13, 4
  s_cbranch_scc1 L_lwd_31
  s_sleep 1
  s_sub_u32 s12, s12, 1
  s_cmp_lg_u32 s12, 0
  s_cbranch_scc1 L_lw_30
L_lwd_31:
  s_setprio 2
  s_add_u32 m0, s68, 20480
  s_nop 0
  buffer_load_dwordx4 v37, s[32:35], s70 offen lds
  s_add_u32 m0, s68, 21504
  s_nop 0
  buffer_load_dwordx4 v38, s[32:35], s70 offen lds
  s_add_u32 s70, s70, 14336
  s_cmp_ge_u32 s70, 401408
  s_cselect_b32 s70, 0, s70
  buffer_load_dwordx4 v[208:211], v26, s[44:47], s71 offen sc1
  buffer_load_dwordx4 v[212:215], v27, s[44:47], s71 offen sc1
  s_add_u32 s71, s71, 1024
  s_cmp_ge_u32 s71, 28672
  s_cselect_b32 s71, 0, s71
  s_waitcnt vmcnt(42)
  ds_read_b64_tr_b16 v[224:225], v20 offset:0
  ds_read_b64_tr_b16 v[226:227], v20 offset:1024
  ds_read_b64_tr_b16 v[228:229], v21 offset:0
  ds_read_b64_tr_b16 v[230:231], v21 offset:1024
  s_waitcnt lgkmcnt(4)
  v_mfma_f32_32x32x16_bf16 v[64:79], v[232:235], v[216:219], v[64:79]
  v_mfma_f32_32x32x16_bf16 v[80:95], v[236:239], v[216:219], v[80:95]
  v_mfma_f32_32x32x16_bf16 v[96:111], v[232:235], v[220:223], v[96:111]
  v_mfma_f32_32x32x16_bf16 v[112:127], v[236:239], v[220:223], v[112:127]
  s_add_u32 m0, s68, 22528
  s_nop 0
  buffer_load_dwordx4 v37, s[32:35], s70 offen lds
  s_add_u32 m0, s68, 23552
  s_nop 0
  buffer_load_dwordx4 v38, s[32:35], s70 offen lds
  s_add_u32 s70, s70, 14336
  s_cmp_ge_u32 s70, 401408
  s_cselect_b32 s70, 0, s70
  buffer_load_dwordx4 v[216:219], v26, s[44:47], s71 offen sc1
  buffer_load_dwordx4 v[220:223], v27, s[44:47], s71 offen sc1
  s_add_u32 s71, s71, 1024
  s_cmp_ge_u32 s71, 28672
  s_cselect_b32 s71, 0, s71
  s_waitcnt vmcnt(42)
  ds_read_b64_tr_b16 v[232:233], v20 offset:2048
  ds_read_b64_tr_b16 v[234:235], v20 offset:3072
  ds_read_b64_tr_b16 v[236:237], v21 offset:2048
  ds_read_b64_tr_b16 v[238:239], v21 offset:3072
  s_waitcnt lgkmcnt(4)
  v_mfma_f32_32x32x16_bf16 v[64:79], v[224:227], v[128:131], v[64:79]
  v_mfma_f32_32x32x16_bf16 v[80:95], v[228:231], v[128:131], v[80:95]
  v_mfma_f32_32x32x16_bf16 v[96:111], v[224:227], v[132:135], v[96:111]
  v_mfma_f32_32x32x16_bf16 v[112:127], v[228:231], v[132:135], v[112:127]
  s_add_u32 m0, s68, 0
  s_nop 0
  buffer_load_dwordx4 v37, s[32:35], s70 offen lds
  s_add_u32 m0, s68, 1024
  s_nop 0
  buffer_load_dwordx4 v38, s[32:35], s70 offen lds
  s_add_u32 s70, s70, 14336
  s_cmp_ge_u32 s70, 401408
  s_cselect_b32 s70, 0, s70
  buffer_load_dwordx4 v[128:131], v26, s[44:47], s71 offen sc1
  buffer_load_dwordx4 v[132:135], v27, s[44:47], s71 offen sc1
  s_add_u32 s71, s71, 1024
  s_cmp_ge_u32 s71, 28672
  s_cselect_b32 s71, 0, s71
  s_waitcnt vmcnt(42)
  ds_read_b64_tr_b16 v[224:225], v20 offset:4096
  ds_read_b64_tr_b16 v[226:227], v20 offset:5120
  ds_read_b64_tr_b16 v[228:229], v21 offset:4096
  ds_read_b64_tr_b16 v[230:231], v21 offset:5120
  s_waitcnt lgkmcnt(4)
  v_mfma_f32_32x32x16_bf16 v[64:79], v[232:235], v[136:139], v[64:79]
  v_mfma_f32_32x32x16_bf16 v[80:95], v[236:239], v[136:139], v[80:95]
  v_mfma_f32_32x32x16_bf16 v[96:111], v[232:235], v[140:143], v[96:111]
  v_mfma_f32_32x32x16_bf16 v[112:127], v[236:239], v[140:143], v[112:127]
  s_add_u32 m0, s68, 2048
  s_nop 0
  buffer_load_dwordx4 v37, s[32:35], s70 offen lds
  s_add_u32 m0, s68, 3072
  s_nop 0
  buffer_load_dwordx4 v38, s[32:35], s70 offen lds
  s_add_u32 s70, s70, 14336
  s_cmp_ge_u32 s70, 401408
  s_cselect_b32 s70, 0, s70
  buffer_load_dwordx4 v[136:139], v26, s[44:47], s71 offen sc1
  buffer_load_dwordx4 v[140:143], v27, s[44:47], s71 offen sc1
  s_add_u32 s71, s71, 1024
  s_cmp_ge_u32 s71, 28672
  s_cselect_b32 s71, 0, s71
  s_waitcnt vmcnt(42)
  ds_read_b64_tr_b16 v[232:233], v20 offset:6144
  ds_read_b64_tr_b16 v[234:235], v20 offset:7168
  ds_read_b64_tr_b16 v[236:237], v21 offset:6144
  ds_read_b64_tr_b16 v[238:239], v21 offset:7168
  s_waitcnt lgkmcnt(4)
  v_mfma_f32_32x32x16_bf16 v[64:79], v[224:227], v[144:147], v[64:79]
  v_mfma_f32_32x32x16_bf16 v[80:95], v[228:231], v[144:147], v[80:95]
  v_mfma_f32_32x32x16_bf16 v[96:111], v[224:227], v[148:151], v[96:111]
  v_mfma_f32_32x32x16_bf16 v[112:127], v[228:231], v[148:151], v[112:127]
  s_add_u32 m0, s68, 4096
  s_nop 0
  buffer_load_dwordx4 v37, s[32:35], s70 offen lds
  s_add_u32 m0, s68, 5120
  s_nop 0
  buffer_load_dwordx4 v38, s[32:35], s70 offen lds
  s_add_u32 s70, s70, 14336
  s_cmp_ge_u32 s70, 401408
  s_cselect_b32 s70, 0, s70
  buffer_load_dwordx4 v[144:147], v26, s[44:47], s71 offen sc1
  buffer_load_dwordx4 v[148:151], v27, s[44:47], s71 offen sc1
  s_add_u32 s71, s71, 1024
  s_cmp_ge_u32 s71, 28672
  s_cselect_b32 s71, 0, s71
  s_waitcnt vmcnt(42)
  ds_read_b64_tr_b16 v[224:225], v20 offset:8192
  ds_read_b64_tr_b16 v[226:227], v20 offset:9216
  ds_read_b64_tr_b16 v[228:229], v21 offset:8192
  ds_read_b64_tr_b16 v[230:231], v21 offset:9216
  s_waitcnt lgkmcnt(4)
  v_mfma_f32_32x32x16_bf16 v[64:79], v[232:235], v[152:155], v[64:79]
  v_mfma_f32_32x32x16_bf16 v[80:95], v[236:239], v[152:155], v[80:95]
  v_mfma_f32_32x32x16_bf16 v[96:111], v[232:235], v[156:159], v[96:111]
  v_mfma_f32_32x32x16_bf16 v[112:127], v[236:239], v[156:159], v[112:127]
  s_add_u32 m0, s68, 6144
  s_nop 0
  buffer_load_dwordx4 v37, s[32:35], s70 offen lds
  s_add_u32 m0, s68, 7168
  s_nop 0
  buffer_load_dwordx4 v38, s[32:35], s70 offen lds
  s_add_u32 s70, s70, 14336
  s_cmp_ge_u32 s70, 401408
  s_cselect_b32 s70, 0, s70
  buffer_load_dwordx4 v[152:155], v26, s[44:47], s71 offen sc1
  buffer_load_dwordx4 v[156:159], v27, s[44:47], s71 offen sc1
  s_add_u32 s71, s71, 1024
  s_cmp_ge_u32 s71, 28672
  s_cselect_b32 s71, 0, s71
  s_waitcnt vmcnt(42)
  ds_read_b64_tr_b16 v[232:233], v20 offset:10240
  ds_read_b64_tr_b16 v[234:235], v20 offset:11264
  ds_read_b64_tr_b16 v[236:237], v21 offset:10240
  ds_read_b64_tr_b16 v[238:239], v21 offset:11264
  s_waitcnt lgkmcnt(4)
  v_mfma_f32_32x32x16_bf16 v[64:79], v[224:227], v[160:163], v[64:79]
  v_mfma_f32_32x32x16_bf16 v[80:95], v[228:231], v[160:163], v[80:95]
  v_mfma_f32_32x32x16_bf16 v[96:111], v[224:227], v[164:167], v[96:111]
  v_mfma_f32_32x32x16_bf16 v[112:127], v[228:231], v[164:167], v[112:127]
  s_mul_i32 s12, s64, 100352
  s_add_u32 s12, s12, 0
  s_add_u32 m0, s68, 8192
  s_nop 0
  buffer_load_dwordx4 v24, s[24:27], s12 offen lds
  s_add_u32 m0, s68, 9216
  s_nop 0
  buffer_load_dwordx4 v25, s[24:27], s12 offen lds
  s_waitcnt vmcnt(40)
  ds_read_b64_tr_b16 v[224:225], v20 offset:12288
  ds_read_b64_tr_b16 v[226:227], v20 offset:13312
  ds_read_b64_tr_b16 v[228:229], v21 offset:12288
  ds_read_b64_tr_b16 v[230:231], v21 offset:13312
  s_waitcnt lgkmcnt(4)
  v_mfma_f32_32x32x16_bf16 v[64:79], v[232:235], v[168:171], v[64:79]
  v_mfma_f32_32x32x16_bf16 v[80:95], v[236:239], v[168:171], v[80:95]
  v_mfma_f32_32x32x16_bf16 v[96:111], v[232:235], v[172:175], v[96:111]
  v_mfma_f32_32x32x16_bf16 v[112:127], v[236:239], v[172:175], v[112:127]
  s_mul_i32 s12, s64, 100352
  s_add_u32 s12, s12, 14336
  s_add_u32 m0, s68, 10240
  s_nop 0
  buffer_load_dwordx4 v24, s[24:27], s12 offen lds
  s_add_u32 m0, s68, 11264
  s_nop 0
  buffer_load_dwordx4 v25, s[24:27], s12 offen lds
  s_waitcnt vmcnt(38)
  ds_read_b64_tr_b16 v[232:233], v20 offset:14336
  ds_read_b64_tr_b16 v[234:235], v20 offset:15360
  ds_read_b64_tr_b16 v[236:237], v21 offset:14336
  ds_read_b64_tr_b16 v[238:239], v21 offset:15360
  s_waitcnt lgkmcnt(4)
  v_mfma_f32_32x32x16_bf16 v[64:79], v[224:227], v[176:179], v[64:79]
  v_mfma_f32_32x32x16_bf16 v[80:95], v[228:231], v[176:179], v[80:95]
  v_mfma_f32_32x32x16_bf16 v[96:111], v[224:227], v[180:183], v[96:111]
  v_mfma_f32_32x32x16_bf16 v[112:127], v[228:231], v[180:183], v[112:127]
  s_mul_i32 s12, s64, 100352
  s_add_u32 s12, s12, 25088
  s_add_u32 m0, s68, 12288
  s_nop 0
  buffer_load_dwordx4 v24, s[24:27], s12 offen lds
  s_add_u32 m0, s68, 13312
  s_nop 0
  buffer_load_dwordx4 v25, s[24:27], s12 offen lds
  s_waitcnt vmcnt(36)
  ds_read_b64_tr_b16 v[224:225], v20 offset:16384
  ds_read_b64_tr_b16 v[226:227], v20 offset:17408
  ds_read_b64_tr_b16 v[228:229], v21 offset:16384
  ds_read_b64_tr_b16 v[230:231], v21 offset:17408
  s_waitcnt lgkmcnt(4)
  v_mfma_f32_32x32x16_bf16 v[64:79], v[232:235], v[184:187], v[64:79]
  v_mfma_f32_32x32x16_bf16 v[80:95], v[236:239], v[184:187], v[80:95]
  v_mfma_f32_32x32x16_bf16 v[96:111], v[232:235], v[188:191], v[96:111]
  v_mfma_f32_32x32x16_bf16 v[112:127], v[236:239], v[188:191], v[112:127]
  s_mul_i32 s12, s64, 100352
  s_add_u32 s12, s12, 39424
  s_add_u32 m0, s68, 14336
  s_nop 0
  buffer_load_dwordx4 v24, s[24:27], s12 offen lds
  s_add_u32 m0, s68, 15360
  s_nop 0
  buffer_load_dwordx4 v25, s[24:27], s12 offen lds
  s_waitcnt vmcnt(34)
  ds_read_b64_tr_b16 v[232:233], v20 offset:18432
  ds_read_b64_tr_b16 v[234:235], v20 offset:19456
  ds_read_b64_tr_b16 v[236:237], v21 offset:18432
  ds_read_b64_tr_b16 v[238:239], v21 offset:19456
  s_waitcnt lgkmcnt(4)
  v_mfma_f32_32x32x16_bf16 v[64:79], v[224:227], v[192:195], v[64:79]
  v_mfma_f32_32x32x16_bf16 v[80:95], v[228:231], v[192:195], v[80:95]
  v_mfma_f32_32x32x16_bf16 v[96:111], v[224:227], v[196:199], v[96:111]
  v_mfma_f32_32x32x16_bf16 v[112:127], v[228:231], v[196:199], v[112:127]
  s_mul_i32 s12, s64, 100352
  s_add_u32 s12, s12, 50176
  s_add_u32 m0, s68, 16384
  s_nop 0
  buffer_load_dwordx4 v24, s[24:27], s12 offen lds
  s_add_u32 m0, s68, 17408
  s_nop 0
  buffer_load_dwordx4 v25, s[24:27], s12 offen lds
  s_waitcnt vmcnt(32)
  ds_read_b64_tr_b16 v[224:225], v20 offset:20480
  ds_read_b64_tr_b16 v[226:227], v20 offset:21504
  ds_read_b64_tr_b16 v[228:229], v21 offset:20480
  ds_read_b64_tr_b16 v[230:231], v21 offset:21504
  s_waitcnt lgkmcnt(4)
  v_mfma_f32_32x32x16_bf16 v[64:79], v[232:235], v[200:203], v[64:79]
  v_mfma_f32_32x32x16_bf16 v[80:95], v[236:239], v[200:203], v[80:95]
  v_mfma_f32_32x32x16_bf16 v[96:111], v[232:235], v[204:207], v[96:111]
  v_mfma_f32_32x32x16_bf16 v[112:127], v[236:239], v[204:207], v[112:127]
  s_mul_i32 s12, s64, 100352
  s_add_u32 s12, s12, 64512
  s_add_u32 m0, s68, 18432
  s_nop 0
  buffer_load_dwordx4 v24, s[24:27], s12 offen lds
  s_add_u32 m0, s68, 19456
  s_nop 0
  buffer_load_dwordx4 v25, s[24:27], s12 offen lds
  s_waitcnt vmcnt(30)
  ds_read_b64_tr_b16 v[232:233], v20 offset:22528
  ds_read_b64_tr_b16 v[234:235], v20 offset:23552
  ds_read_b64_tr_b16 v[236:237], v21 offset:22528
  ds_read_b64_tr_b16 v[238:239], v21 offset:23552
  s_waitcnt lgkmcnt(4)
  v_mfma_f32_32x32x16_bf16 v[64:79], v[224:227], v[208:211], v[64:79]
  v_mfma_f32_32x32x16_bf16 v[80:95], v[228:231], v[208:211], v[80:95]
  v_mfma_f32_32x32x16_bf16 v[96:111], v[224:227], v[212:215], v[96:111]
  v_mfma_f32_32x32x16_bf16 v[112:127], v[228:231], v[212:215], v[112:127]
  s_mul_i32 s12, s64, 100352
  s_add_u32 s12, s12, 75264
  s_add_u32 m0, s68, 20480
  s_nop 0
  buffer_load_dwordx4 v24, s[24:27], s12 offen lds
  s_add_u32 m0, s68, 21504
  s_nop 0
  buffer_load_dwordx4 v25, s[24:27], s12 offen lds
  s_waitcnt vmcnt(28)
  ds_read_b64_tr_b16 v[224:225], v20 offset:0
  ds_read_b64_tr_b16 v[226:227], v20 offset:1024
  ds_read_b64_tr_b16 v[228:229], v21 offset:0
  ds_read_b64_tr_b16 v[230:231], v21 offset:1024
  s_waitcnt lgkmcnt(4)
  v_mfma_f32_32x32x16_bf16 v[64:79], v[232:235], v[216:219], v[64:79]
  v_mfma_f32_32x32x16_bf16 v[80:95], v[236:239], v[216:219], v[80:95]
  v_mfma_f32_32x32x16_bf16 v[96:111], v[232:235], v[220:223], v[96:111]
  v_mfma_f32_32x32x16_bf16 v[112:127], v[236:239], v[220:223], v[112:127]
  s_mul_i32 s12, s64, 100352
  s_add_u32 s12, s12, 89600
  s_add_u32 m0, s68, 22528
  s_nop 0
  buffer_load_dwordx4 v24, s[24:27], s12 offen lds
  s_add_u32 m0, s68, 23552
  s_nop 0
  buffer_load_dwordx4 v25, s[24:27], s12 offen lds
  s_waitcnt vmcnt(26)
  ds_read_b64_tr_b16 v[232:233], v20 offset:2048
  ds_read_b64_tr_b16 v[234:235], v20 offset:3072
  ds_read_b64_tr_b16 v[236:237], v21 offset:2048
  ds_read_b64_tr_b16 v[238:239], v21 offset:3072
  s_waitcnt lgkmcnt(4)
  v_mfma_f32_32x32x16_bf16 v[64:79], v[224:227], v[128:131], v[64:79]
  v_mfma_f32_32x32x16_bf16 v[80:95], v[228:231], v[128:131], v[80:95]
  v_mfma_f32_32x32x16_bf16 v[96:111], v[224:227], v[132:135], v[96:111]
  v_mfma_f32_32x32x16_bf16 v[112:127], v[228:231], v[132:135], v[112:127]
  s_waitcnt vmcnt(22)
  ds_read_b64_tr_b16 v[224:225], v20 offset:4096
  ds_read_b64_tr_b16 v[226:227], v20 offset:5120
  ds_read_b64_tr_b16 v[228:229], v21 offset:4096
  ds_read_b64_tr_b16 v[230:231], v21 offset:5120
  s_waitcnt lgkmcnt(4)
  v_mfma_f32_32x32x16_bf16 v[64:79], v[232:235], v[136:139], v[64:79]
  v_mfma_f32_32x32x16_bf16 v[80:95], v[236:239], v[136:139], v[80:95]
  v_mfma_f32_32x32x16_bf16 v[96:111], v[232:235], v[140:143], v[96:111]
  v_mfma_f32_32x32x16_bf16 v[112:127], v[236:239], v[140:143], v[112:127]
  s_waitcnt vmcnt(18)
  ds_read_b64_tr_b16 v[232:233], v20 offset:6144
  ds_read_b64_tr_b16 v[234:235], v20 offset:7168
  ds_read_b64_tr_b16 v[236:237], v21 offset:6144
  ds_read_b64_tr_b16 v[238:239], v21 offset:7168
  s_waitcnt lgkmcnt(4)
  v_mfma_f32_32x32x16_bf16 v[64:79], v[224:227], v[144:147], v[64:79]
  v_mfma_f32_32x32x16_bf16 v[80:95], v[228:231], v[144:147], v[80:95]
  v_mfma_f32_32x32x16_bf16 v[96:111], v[224:227], v[148:151], v[96:111]
  v_mfma_f32_32x32x16_bf16 v[112:127], v[228:231], v[148:151], v[112:127]
  s_waitcnt vmcnt(14)
  ds_read_b64_tr_b16 v[224:225], v20 offset:8192
  ds_read_b64_tr_b16 v[226:227], v20 offset:9216
  ds_read_b64_tr_b16 v[228:229], v21 offset:8192
  ds_read_b64_tr_b16 v[230:231], v21 offset:9216
  s_waitcnt lgkmcnt(4)
  v_mfma_f32_32x32x16_bf16 v[64:79], v[232:235], v[152:155], v[64:79]
  v_mfma_f32_32x32x16_bf16 v[80:95], v[236:239], v[152:155], v[80:95]
  v_mfma_f32_32x32x16_bf16 v[96:111], v[232:235], v[156:159], v[96:111]
  v_mfma_f32_32x32x16_bf16 v[112:127], v[236:239], v[156:159], v[112:127]
  v_and_b32 v12, 3, v1
  v_bfe_u32 v13, v1, 2, 1
  v_lshl_add_u32 v12, v13, 4, v12
  s_lshl_b32 s12, s69, 4
  s_lshl_b32 s13, s64, 2
  s_add_u32 s12, s12, s13
  v_add_u32 v12, s12, v12
  v_lshlrev_b32 v12, 7, v12
  v_add_u32 v12, 262144, v12
  s_mul_i32 s73, s64, -20480
  s_add_u32 s73, s73, 114688
  v_and_b32 v36, 0xffff0000, v32
  v_and_b32 v39, 0xffff0000, v34
  s_lshr_b32 s12, s64, 1
  s_add_u32 s72, s69, s12
  s_lshl_b32 s12, s72, 5
  v_add_u32 v13, s12, v2
  v_mul_u32_u24 v13, 896, v13
  v_lshl_add_u32 v13, v3, 4, v13
  s_lshl_b32 s12, s11, 7
  s_and_b32 s13, s64, 1
  s_lshl_b32 s13, s13, 6
  s_add_u32 s12, s12, s13
  v_add_u32 v28, s12, v13
  v_mul_f32 v64, v64, v36
  v_mul_f32 v65, v65, v36
  v_mul_f32 v66, v66, v36
  v_mul_f32 v67, v67, v36
  v_mul_f32 v68, v68, v36
  v_mul_f32 v69, v69, v36
  v_mul_f32 v70, v70, v36
  v_mul_f32 v71, v71, v36
  v_mul_f32 v72, v72, v36
  v_mul_f32 v73, v73, v36
  v_mul_f32 v74, v74, v36
  v_mul_f32 v75, v75, v36
  v_mul_f32 v76, v76, v36
  v_mul_f32 v77, v77, v36
  v_mul_f32 v78, v78, v36
  v_mul_f32 v79, v79, v36
  v_mul_f32 v80, v80, v36
  v_mul_f32 v81, v81, v36
  v_mul_f32 v82, v82, v36
  v_mul_f32 v83, v83, v36
  v_mul_f32 v84, v84, v36
  v_mul_f32 v85, v85, v36
  v_mul_f32 v86, v86, v36
  v_mul_f32 v87, v87, v36
  v_mul_f32 v88, v88, v36
  v_mul_f32 v89, v89, v36
  v_mul_f32 v90, v90, v36
  v_mul_f32 v91, v91, v36
  v_mul_f32 v92, v92, v36
  v_mul_f32 v93, v93, v36
  v_mul_f32 v94, v94, v36
  v_mul_f32 v95, v95, v36
  v_mul_f32 v96, v96, v39
  v_mul_f32 v97, v97, v39
  v_mul_f32 v98, v98, v39
  v_mul_f32 v99, v99, v39
  v_mul_f32 v100, v100, v39
  v_mul_f32 v101, v101, v39
  v_mul_f32 v102, v102, v39
  v_mul_f32 v103, v103, v39
  v_mul_f32 v104, v104, v39
  v_mul_f32 v105, v105, v39
  v_mul_f32 v106, v106, v39
  v_mul_f32 v107, v107, v39
  v_mul_f32 v108, v108, v39
  v_mul_f32 v109, v109, v39
  v_mul_f32 v110, v110, v39
  v_mul_f32 v111, v111, v39
  v_mul_f32 v112, v112, v39
  v_mul_f32 v113, v113, v39
  v_mul_f32 v114, v114, v39
  v_mul_f32 v115, v115, v39
  v_mul_f32 v116, v116, v39
  v_mul_f32 v117, v117, v39
  v_mul_f32 v118, v118, v39
  v_mul_f32 v119, v119, v39
  v_mul_f32 v120, v120, v39
  v_mul_f32 v121, v121, v39
  v_mul_f32 v122, v122, v39
  v_mul_f32 v123, v123, v39
  v_mul_f32 v124, v124, v39
  v_mul_f32 v125, v125, v39
  v_mul_f32 v126, v126, v39
  v_mul_f32 v127, v127, v39
  s_mov_b32 s12, 100000
  buffer_load_dword v56, v12, s[44:47], 0 offen sc1
  s_sleep 6
L_poll_32:
  buffer_load_dword v57, v12, s[44:47], 0 offen sc1
  s_waitcnt vmcnt(1)
  v_xor_b32 v56, s8, v56
  v_cmp_ne_u32 vcc, 0, v56
  s_nop 0
  s_cbranch_vccz L_polld_33
  s_sleep 6
  buffer_load_dword v56, v12, s[44:47], 0 offen sc1
  s_waitcnt vmcnt(1)
  v_xor_b32 v57, s8, v57
  v_cmp_ne_u32 vcc, 0, v57
  s_nop 0
  s_cbranch_vccz L_polld_33
  s_sleep 6
  s_sub_u32 s12, s12, 1
  s_cmp_lg_u32 s12, 0
  s_cbranch_scc1 L_poll_32
L_polld_33:
  buffer_load_dwordx4 v[160:163], v26, s[44:47], s73 offen offset:0 sc1
  buffer_load_dwordx4 v[164:167], v27, s[44:47], s73 offen offset:0 sc1
  buffer_load_dwordx4 v[168:171], v26, s[44:47], s73 offen offset:1024 sc1
  buffer_load_dwordx4 v[172:175], v27, s[44:47], s73 offen offset:1024 sc1
  buffer_load_dwordx4 v[176:179], v26, s[44:47], s73 offen offset:2048 sc1
  buffer_load_dwordx4 v[180:183], v27, s[44:47], s73 offen offset:2048 sc1
  buffer_load_dwordx4 v[184:187], v26, s[44:47], s73 offen offset:3072 sc1
  buffer_load_dwordx4 v[188:191], v27, s[44:47], s73 offen offset:3072 sc1
  s_add_u32 s73, s73, 4096
  buffer_load_dwordx4 v[192:195], v26, s[44:47], s73 offen offset:0 sc1
  buffer_load_dwordx4 v[196:199], v27, s[44:47], s73 offen offset:0 sc1
  buffer_load_dwordx4 v[200:203], v26, s[44:47], s73 offen offset:1024 sc1
  buffer_load_dwordx4 v[204:207], v27, s[44:47], s73 offen offset:1024 sc1
  buffer_load_dwordx4 v[208:211], v26, s[44:47], s73 offen offset:2048 sc1
  buffer_load_dwordx4 v[212:215], v27, s[44:47], s73 offen offset:2048 sc1
  buffer_load_dwordx4 v[216:219], v26, s[44:47], s73 offen offset:3072 sc1
  buffer_load_dwordx4 v[220:223], v27, s[44:47], s73 offen offset:3072 sc1
  s_waitcnt vmcnt(14)
  ds_read_b64_tr_b16 v[232:233], v20 offset:10240
  ds_read_b64_tr_b16 v[234:235], v20 offset:11264
  ds_read_b64_tr_b16 v[236:237], v21 offset:10240
  ds_read_b64_tr_b16 v[238:239], v21 offset:11264
  s_waitcnt lgkmcnt(4)
  v_mfma_f32_32x32x16_bf16 v[64:79], v[224:227], v[160:163], v[64:79]
  v_mfma_f32_32x32x16_bf16 v[80:95], v[228:231], v[160:163], v[80:95]
  v_mfma_f32_32x32x16_bf16 v[96:111], v[224:227], v[164:167], v[96:111]
  v_mfma_f32_32x32x16_bf16 v[112:127], v[228:231], v[164:167], v[112:127]
  s_waitcnt vmcnt(12)
  ds_read_b64_tr_b16 v[224:225], v20 offset:12288
  ds_read_b64_tr_b16 v[226:227], v20 offset:13312
  ds_read_b64_tr_b16 v[228:229], v21 offset:12288
  ds_read_b64_tr_b16 v[230:231], v21 offset:13312
  s_waitcnt lgkmcnt(4)
  v_mfma_f32_32x32x16_bf16 v[64:79], v[232:235], v[168:171], v[64:79]
  v_mfma_f32_32x32x16_bf16 v[80:95], v[236:239], v[168:171], v[80:95]
  v_mfma_f32_32x32x16_bf16 v[96:111], v[232:235], v[172:175], v[96:111]
  v_mfma_f32_32x32x16_bf16 v[112:127], v[236:239], v[172:175], v[112:127]
  s_waitcnt vmcnt(10)
  ds_read_b64_tr_b16 v[232:233], v20 offset:14336
  ds_read_b64_tr_b16 v[234:235], v20 offset:15360
  ds_read_b64_tr_b16 v[236:237], v21 offset:14336
  ds_read_b64_tr_b16 v[238:239], v21 offset:15360
  s_waitcnt lgkmcnt(4)
  v_mfma_f32_32x32x16_bf16 v[64:79], v[224:227], v[176:179], v[64:79]
  v_mfma_f32_32x32x16_bf16 v[80:95], v[228:231], v[176:179], v[80:95]
  v_mfma_f32_32x32x16_bf16 v[96:111], v[224:227], v[180:183], v[96:111]
  v_mfma_f32_32x32x16_bf16 v[112:127], v[228:231], v[180:183], v[112:127]
  s_waitcnt vmcnt(8)
  ds_read_b64_tr_b16 v[224:225], v20 offset:16384
  ds_read_b64_tr_b16 v[226:227], v20 offset:17408
  ds_read_b64_tr_b16 v[228:229], v21 offset:16384
  ds_read_b64_tr_b16 v[230:231], v21 offset:17408
  s_waitcnt lgkmcnt(4)
  v_mfma_f32_32x32x16_bf16 v[64:79], v[232:235], v[184:187], v[64:79]
  v_mfma_f32_32x32x16_bf16 v[80:95], v[236:239], v[184:187], v[80:95]
  v_mfma_f32_32x32x16_bf16 v[96:111], v[232:235], v[188:191], v[96:111]
  v_mfma_f32_32x32x16_bf16 v[112:127], v[236:239], v[188:191], v[112:127]
  s_waitcnt vmcnt(6)
  ds_read_b64_tr_b16 v[232:233], v20 offset:18432
  ds_read_b64_tr_b16 v[234:235], v20 offset:19456
  ds_read_b64_tr_b16 v[236:237], v21 offset:18432
  ds_read_b64_tr_b16 v[238:239], v21 offset:19456
  s_waitcnt lgkmcnt(4)
  v_mfma_f32_32x32x16_bf16 v[64:79], v[224:227], v[192:195], v[64:79]
  v_mfma_f32_32x32x16_bf16 v[80:95], v[228:231], v[192:195], v[80:95]
  v_mfma_f32_32x32x16_bf16 v[96:111], v[224:227], v[196:199], v[96:111]
  v_mfma_f32_32x32x16_bf16 v[112:127], v[228:231], v[196:199], v[112:127]
  s_waitcnt vmcnt(4)
  ds_read_b64_tr_b16 v[224:225], v20 offset:20480
  ds_read_b64_tr_b16 v[226:227], v20 offset:21504
  ds_read_b64_tr_b16 v[228:229], v21 offset:20480
  ds_read_b64_tr_b16 v[230:231], v21 offset:21504
  s_waitcnt lgkmcnt(4)
  v_mfma_f32_32x32x16_bf16 v[64:79], v[232:235], v[200:203], v[64:79]
  v_mfma_f32_32x32x16_bf16 v[80:95], v[236:239], v[200:203], v[80:95]
  v_mfma_f32_32x32x16_bf16 v[96:111], v[232:235], v[204:207], v[96:111]
  v_mfma_f32_32x32x16_bf16 v[112:127], v[236:239], v[204:207], v[112:127]
  s_waitcnt vmcnt(2)
  ds_read_b64_tr_b16 v[232:233], v20 offset:22528
  ds_read_b64_tr_b16 v[234:235], v20 offset:23552
  ds_read_b64_tr_b16 v[236:237], v21 offset:22528
  ds_read_b64_tr_b16 v[238:239], v21 offset:23552
  s_waitcnt lgkmcnt(4)
  v_mfma_f32_32x32x16_bf16 v[64:79], v[224:227], v[208:211], v[64:79]
  v_mfma_f32_32x32x16_bf16 v[80:95], v[228:231], v[208:211], v[80:95]
  v_mfma_f32_32x32x16_bf16 v[96:111], v[224:227], v[212:215], v[96:111]
  v_mfma_f32_32x32x16_bf16 v[112:127], v[228:231], v[212:215], v[112:127]
  s_waitcnt vmcnt(0)
  s_waitcnt lgkmcnt(0)
  v_mfma_f32_32x32x16_bf16 v[64:79], v[232:235], v[216:219], v[64:79]
  v_mfma_f32_32x32x16_bf16 v[80:95], v[236:239], v[216:219], v[80:95]
  v_mfma_f32_32x32x16_bf16 v[96:111], v[232:235], v[220:223], v[96:111]
  v_mfma_f32_32x32x16_bf16 v[112:127], v[236:239], v[220:223], v[112:127]
  v_add_u32 v12, s68, v4
  s_nop 8
  ds_write_b128 v12, v[80:83] offset:0
  ds_write_b128 v12, v[84:87] offset:1024
  ds_write_b128 v12, v[88:91] offset:2048
  ds_write_b128 v12, v[92:95] offset:3072
  ds_write_b128 v12, v[96:99] offset:4096
  ds_write_b128 v12, v[100:103] offset:5120
  ds_write_b128 v12, v[104:107] offset:6144
  ds_write_b128 v12, v[108:111] offset:7168
  ds_write_b128 v12, v[112:115] offset:8192
  ds_write_b128 v12, v[116:119] offset:9216
  ds_write_b128 v12, v[120:123] offset:10240
  ds_write_b128 v12, v[124:127] offset:11264
  s_xor_b32 s12, s64, 1
  s_mul_i32 s12, s12, 24576
  v_add_u32 v16, s12, v4
  s_xor_b32 s12, s64, 2
  s_mul_i32 s12, s12, 24576
  v_add_u32 v17, s12, v4
  s_xor_b32 s12, s64, 3
  s_mul_i32 s12, s12, 24576
  v_add_u32 v18, s12, v4
  s_waitcnt lgkmcnt(0)
  v_mov_b32 v12, 159748
  v_mov_b32 v13, 1
  s_mov_b64 exec, 1
  ds_add_u32 v12, v13
  s_mov_b64 exec, -1
  v_mov_b32 v12, 159748
  s_mov_b32 s12, 1000000
L_lw_34:
  ds_read_b32 v13, v12
  s_waitcnt lgkmcnt(0)
  v_readfirstlane_b32 s13, v13
  s_nop 0
  s_cmp_ge_u32 s13, 4
  s_cbranch_scc1 L_lwd_35

  s_sub_u32 s12, s12, 1
  s_cmp_lg_u32 s12, 0
  s_cbranch_scc1 L_lw_34
L_lwd_35:
  ds_read_b128 v[128:131], v16 offset:0
  ds_read_b128 v[132:135], v16 offset:1024
  ds_read_b128 v[136:139], v16 offset:2048
  ds_read_b128 v[140:143], v16 offset:3072
  ds_read_b128 v[144:147], v17 offset:4096
  ds_read_b128 v[148:151], v17 offset:5120
  ds_read_b128 v[152:155], v17 offset:6144
  ds_read_b128 v[156:159], v17 offset:7168
  ds_read_b128 v[160:163], v18 offset:8192
  ds_read_b128 v[164:167], v18 offset:9216
  ds_read_b128 v[168:171], v18 offset:10240
  ds_read_b128 v[172:175], v18 offset:11264
  s_waitcnt lgkmcnt(8)
  v_add_f32 v64, v64, v128
  v_add_f32 v65, v65, v129
  v_add_f32 v66, v66, v130
  v_add_f32 v67, v67, v131
  v_add_f32 v68, v68, v132
  v_add_f32 v69, v69, v133
  v_add_f32 v70, v70, v134
  v_add_f32 v71, v71, v135
  v_add_f32 v72, v72, v136
  v_add_f32 v73, v73, v137
  v_add_f32 v74, v74, v138
  v_add_f32 v75, v75, v139
  v_add_f32 v76, v76, v140
  v_add_f32 v77, v77, v141
  v_add_f32 v78, v78, v142
  v_add_f32 v79, v79, v143
  s_waitcnt lgkmcnt(4)
  v_add_f32 v64, v64, v144
  v_add_f32 v65, v65, v145
  v_add_f32 v66, v66, v146
  v_add_f32 v67, v67, v147
  v_add_f32 v68, v68, v148
  v_add_f32 v69, v69, v149
  v_add_f32 v70, v70, v150
  v_add_f32 v71, v71, v151
  v_add_f32 v72, v72, v152
  v_add_f32 v73, v73, v153
  v_add_f32 v74, v74, v154
  v_add_f32 v75, v75, v155
  v_add_f32 v76, v76, v156
  v_add_f32 v77, v77, v157
  v_add_f32 v78, v78, v158
  v_add_f32 v79, v79, v159
  s_waitcnt lgkmcnt(0)
  v_add_f32 v64, v64, v160
  v_add_f32 v65, v65, v161
  v_add_f32 v66, v66, v162
  v_add_f32 v67, v67, v163
  v_add_f32 v68, v68, v164
  v_add_f32 v69, v69, v165
  v_add_f32 v70, v70, v166
  v_add_f32 v71, v71, v167
  v_add_f32 v72, v72, v168
  v_add_f32 v73, v73, v169
  v_add_f32 v74, v74, v170
  v_add_f32 v75, v75, v171
  v_add_f32 v76, v76, v172
  v_add_f32 v77, v77, v173
  v_add_f32 v78, v78, v174
  v_add_f32 v79, v79, v175
  v_cvt_pk_bf16_f32 v40, v64, v65
  v_cvt_pk_bf16_f32 v41, v66, v67
  v_cvt_pk_bf16_f32 v42, v68, v69
  v_cvt_pk_bf16_f32 v43, v70, v71
  v_cvt_pk_bf16_f32 v44, v72, v73
  v_cvt_pk_bf16_f32 v45, v74, v75
  v_cvt_pk_bf16_f32 v46, v76, v77
  v_cvt_pk_bf16_f32 v47, v78, v79
  v_permlane32_swap_b32 v40, v42
  v_permlane32_swap_b32 v41, v43
  v_permlane32_swap_b32 v44, v46
  v_permlane32_swap_b32 v45, v47
  buffer_store_dwordx4 v[40:43], v28, s[40:43], 0 offen
  buffer_store_dwordx4 v[44:47], v28, s[40:43], 0 offen offset:32
  s_endpgm
L_gate:
  s_lshl_b32 s12, s4, 2
  s_add_u32 s12, s12, s5
  s_sub_u32 s12, s12, 28
  s_lshl_b32 s12, s12, 3
  s_add_u32 s12, s12, s3
  s_lshl_b32 s64, s12, 3
  s_mul_i32 s13, s64, 896
  v_add_u32 v10, s13, v4
  v_mov_b32 v11, 0x7ffffff0
  v_cmp_gt_u32 vcc, 56, v1
  s_nop 1
  v_cndmask_b32 v10, v11, v10, vcc
  buffer_load_dwordx4 v[12:15], v4, s[36:39], 0 offen
  buffer_load_dwordx4 v[32:35], v10, s[16:19], 0 offen offset:0
  buffer_load_dwordx4 v[36:39], v10, s[16:19], 0 offen offset:896
  buffer_load_dwordx4 v[40:43], v10, s[16:19], 0 offen offset:1792
  buffer_load_dwordx4 v[44:47], v10, s[16:19], 0 offen offset:2688
  s_mov_b32 s13, 3584
  buffer_load_dwordx4 v[48:51], v10, s[16:19], s13 offen offset:0
  buffer_load_dwordx4 v[52:55], v10, s[16:19], s13 offen offset:896
  buffer_load_dwordx4 v[56:59], v10, s[16:19], s13 offen offset:1792
  buffer_load_dwordx4 v[60:63], v10, s[16:19], s13 offen offset:2688
  s_cmp_lg_u32 s3, 0
  s_cbranch_scc1 L_g1
  v_mov_b32 v16, 159744
  v_mov_b32 v17, 8
  ds_write_b32 v16, v17
  ds_write_b32 v16, v17 offset:32
L_g1:
  s_waitcnt vmcnt(8) lgkmcnt(0)
  v_readfirstlane_b32 s9, v6
  s_nop 0
  s_mul_i32 s8, s9, 0x9E3779B1
  s_xor_b32 s8, s8, 0x5bd1e995
  s_barrier
  v_lshlrev_b32 v16, 16, v12
  v_and_b32 v17, 0xffff0000, v12
  v_lshlrev_b32 v18, 16, v13
  v_and_b32 v19, 0xffff0000, v13
  v_lshlrev_b32 v20, 16, v14
  v_and_b32 v21, 0xffff0000, v14
  v_lshlrev_b32 v22, 16, v15
  v_and_b32 v23, 0xffff0000, v15
  s_waitcnt vmcnt(0)
  v_lshlrev_b32 v24, 16, v32
  v_and_b32 v25, 0xffff0000, v32
  v_mul_f32 v24, v24, v16
  v_mul_f32 v25, v25, v17
  v_cvt_pk_bf16_f32 v24, v24, v25
  v_lshlrev_b32 v25, 16, v24
  v_and_b32 v24, 0xffff0000, v24
  v_add_f32 v64, v24, v25
  v_lshlrev_b32 v24, 16, v33
  v_and_b32 v25, 0xffff0000, v33
  v_mul_f32 v24, v24, v18
  v_mul_f32 v25, v25, v19
  v_cvt_pk_bf16_f32 v24, v24, v25
  v_lshlrev_b32 v25, 16, v24
  v_and_b32 v24, 0xffff0000, v24
  v_add_f32 v64, v64, v25
  v_add_f32 v64, v64, v24
  v_lshlrev_b32 v24, 16, v34
  v_and_b32 v25, 0xffff0000, v34
  v_mul_f32 v24, v24, v20
  v_mul_f32 v25, v25, v21
  v_cvt_pk_bf16_f32 v24, v24, v25
  v_lshlrev_b32 v25, 16, v24
  v_and_b32 v24, 0xffff0000, v24
  v_add_f32 v64, v64, v25
  v_add_f32 v64, v64, v24
  v_lshlrev_b32 v24, 16, v35
  v_and_b32 v25, 0xffff0000, v35
  v_mul_f32 v24, v24, v22
  v_mul_f32 v25, v25, v23
  v_cvt_pk_bf16_f32 v24, v24, v25
  v_lshlrev_b32 v25, 16, v24
  v_and_b32 v24, 0xffff0000, v24
  v_add_f32 v64, v64, v25
  v_add_f32 v64, v64, v24
  v_lshlrev_b32 v24, 16, v36
  v_and_b32 v25, 0xffff0000, v36
  v_mul_f32 v24, v24, v16
  v_mul_f32 v25, v25, v17
  v_cvt_pk_bf16_f32 v24, v24, v25
  v_lshlrev_b32 v25, 16, v24
  v_and_b32 v24, 0xffff0000, v24
  v_add_f32 v65, v24, v25
  v_lshlrev_b32 v24, 16, v37
  v_and_b32 v25, 0xffff0000, v37
  v_mul_f32 v24, v24, v18
  v_mul_f32 v25, v25, v19
  v_cvt_pk_bf16_f32 v24, v24, v25
  v_lshlrev_b32 v25, 16, v24
  v_and_b32 v24, 0xffff0000, v24
  v_add_f32 v65, v65, v25
  v_add_f32 v65, v65, v24
  v_lshlrev_b32 v24, 16, v38
  v_and_b32 v25, 0xffff0000, v38
  v_mul_f32 v24, v24, v20
  v_mul_f32 v25, v25, v21
  v_cvt_pk_bf16_f32 v24, v24, v25
  v_lshlrev_b32 v25, 16, v24
  v_and_b32 v24, 0xffff0000, v24
  v_add_f32 v65, v65, v25
  v_add_f32 v65, v65, v24
  v_lshlrev_b32 v24, 16, v39
  v_and_b32 v25, 0xffff0000, v39
  v_mul_f32 v24, v24, v22
  v_mul_f32 v25, v25, v23
  v_cvt_pk_bf16_f32 v24, v24, v25
  v_lshlrev_b32 v25, 16, v24
  v_and_b32 v24, 0xffff0000, v24
  v_add_f32 v65, v65, v25
  v_add_f32 v65, v65, v24
  v_lshlrev_b32 v24, 16, v40
  v_and_b32 v25, 0xffff0000, v40
  v_mul_f32 v24, v24, v16
  v_mul_f32 v25, v25, v17
  v_cvt_pk_bf16_f32 v24, v24, v25
  v_lshlrev_b32 v25, 16, v24
  v_and_b32 v24, 0xffff0000, v24
  v_add_f32 v66, v24, v25
  v_lshlrev_b32 v24, 16, v41
  v_and_b32 v25, 0xffff0000, v41
  v_mul_f32 v24, v24, v18
  v_mul_f32 v25, v25, v19
  v_cvt_pk_bf16_f32 v24, v24, v25
  v_lshlrev_b32 v25, 16, v24
  v_and_b32 v24, 0xffff0000, v24
  v_add_f32 v66, v66, v25
  v_add_f32 v66, v66, v24
  v_lshlrev_b32 v24, 16, v42
  v_and_b32 v25, 0xffff0000, v42
  v_mul_f32 v24, v24, v20
  v_mul_f32 v25, v25, v21
  v_cvt_pk_bf16_f32 v24, v24, v25
  v_lshlrev_b32 v25, 16, v24
  v_and_b32 v24, 0xffff0000, v24
  v_add_f32 v66, v66, v25
  v_add_f32 v66, v66, v24
  v_lshlrev_b32 v24, 16, v43
  v_and_b32 v25, 0xffff0000, v43
  v_mul_f32 v24, v24, v22
  v_mul_f32 v25, v25, v23
  v_cvt_pk_bf16_f32 v24, v24, v25
  v_lshlrev_b32 v25, 16, v24
  v_and_b32 v24, 0xffff0000, v24
  v_add_f32 v66, v66, v25
  v_add_f32 v66, v66, v24
  v_lshlrev_b32 v24, 16, v44
  v_and_b32 v25, 0xffff0000, v44
  v_mul_f32 v24, v24, v16
  v_mul_f32 v25, v25, v17
  v_cvt_pk_bf16_f32 v24, v24, v25
  v_lshlrev_b32 v25, 16, v24
  v_and_b32 v24, 0xffff0000, v24
  v_add_f32 v67, v24, v25
  v_lshlrev_b32 v24, 16, v45
  v_and_b32 v25, 0xffff0000, v45
  v_mul_f32 v24, v24, v18
  v_mul_f32 v25, v25, v19
  v_cvt_pk_bf16_f32 v24, v24, v25
  v_lshlrev_b32 v25, 16, v24
  v_and_b32 v24, 0xffff0000, v24
  v_add_f32 v67, v67, v25
  v_add_f32 v67, v67, v24
  v_lshlrev_b32 v24, 16, v46
  v_and_b32 v25, 0xffff0000, v46
  v_mul_f32 v24, v24, v20
  v_mul_f32 v25, v25, v21
  v_cvt_pk_bf16_f32 v24, v24, v25
  v_lshlrev_b32 v25, 16, v24
  v_and_b32 v24, 0xffff0000, v24
  v_add_f32 v67, v67, v25
  v_add_f32 v67, v67, v24
  v_lshlrev_b32 v24, 16, v47
  v_and_b32 v25, 0xffff0000, v47
  v_mul_f32 v24, v24, v22
  v_mul_f32 v25, v25, v23
  v_cvt_pk_bf16_f32 v24, v24, v25
  v_lshlrev_b32 v25, 16, v24
  v_and_b32 v24, 0xffff0000, v24
  v_add_f32 v67, v67, v25
  v_add_f32 v67, v67, v24
  v_lshlrev_b32 v24, 16, v48
  v_and_b32 v25, 0xffff0000, v48
  v_mul_f32 v24, v24, v16
  v_mul_f32 v25, v25, v17
  v_cvt_pk_bf16_f32 v24, v24, v25
  v_lshlrev_b32 v25, 16, v24
  v_and_b32 v24, 0xffff0000, v24
  v_add_f32 v68, v24, v25
  v_lshlrev_b32 v24, 16, v49
  v_and_b32 v25, 0xffff0000, v49
  v_mul_f32 v24, v24, v18
  v_mul_f32 v25, v25, v19
  v_cvt_pk_bf16_f32 v24, v24, v25
  v_lshlrev_b32 v25, 16, v24
  v_and_b32 v24, 0xffff0000, v24
  v_add_f32 v68, v68, v25
  v_add_f32 v68, v68, v24
  v_lshlrev_b32 v24, 16, v50
  v_and_b32 v25, 0xffff0000, v50
  v_mul_f32 v24, v24, v20
  v_mul_f32 v25, v25, v21
  v_cvt_pk_bf16_f32 v24, v24, v25
  v_lshlrev_b32 v25, 16, v24
  v_and_b32 v24, 0xffff0000, v24
  v_add_f32 v68, v68, v25
  v_add_f32 v68, v68, v24
  v_lshlrev_b32 v24, 16, v51
  v_and_b32 v25, 0xffff0000, v51
  v_mul_f32 v24, v24, v22
  v_mul_f32 v25, v25, v23
  v_cvt_pk_bf16_f32 v24, v24, v25
  v_lshlrev_b32 v25, 16, v24
  v_and_b32 v24, 0xffff0000, v24
  v_add_f32 v68, v68, v25
  v_add_f32 v68, v68, v24
  v_lshlrev_b32 v24, 16, v52
  v_and_b32 v25, 0xffff0000, v52
  v_mul_f32 v24, v24, v16
  v_mul_f32 v25, v25, v17
  v_cvt_pk_bf16_f32 v24, v24, v25
  v_lshlrev_b32 v25, 16, v24
  v_and_b32 v24, 0xffff0000, v24
  v_add_f32 v69, v24, v25
  v_lshlrev_b32 v24, 16, v53
  v_and_b32 v25, 0xffff0000, v53
  v_mul_f32 v24, v24, v18
  v_mul_f32 v25, v25, v19
  v_cvt_pk_bf16_f32 v24, v24, v25
  v_lshlrev_b32 v25, 16, v24
  v_and_b32 v24, 0xffff0000, v24
  v_add_f32 v69, v69, v25
  v_add_f32 v69, v69, v24
  v_lshlrev_b32 v24, 16, v54
  v_and_b32 v25, 0xffff0000, v54
  v_mul_f32 v24, v24, v20
  v_mul_f32 v25, v25, v21
  v_cvt_pk_bf16_f32 v24, v24, v25
  v_lshlrev_b32 v25, 16, v24
  v_and_b32 v24, 0xffff0000, v24
  v_add_f32 v69, v69, v25
  v_add_f32 v69, v69, v24
  v_lshlrev_b32 v24, 16, v55
  v_and_b32 v25, 0xffff0000, v55
  v_mul_f32 v24, v24, v22
  v_mul_f32 v25, v25, v23
  v_cvt_pk_bf16_f32 v24, v24, v25
  v_lshlrev_b32 v25, 16, v24
  v_and_b32 v24, 0xffff0000, v24
  v_add_f32 v69, v69, v25
  v_add_f32 v69, v69, v24
  v_lshlrev_b32 v24, 16, v56
  v_and_b32 v25, 0xffff0000, v56
  v_mul_f32 v24, v24, v16
  v_mul_f32 v25, v25, v17
  v_cvt_pk_bf16_f32 v24, v24, v25
  v_lshlrev_b32 v25, 16, v24
  v_and_b32 v24, 0xffff0000, v24
  v_add_f32 v70, v24, v25
  v_lshlrev_b32 v24, 16, v57
  v_and_b32 v25, 0xffff0000, v57
  v_mul_f32 v24, v24, v18
  v_mul_f32 v25, v25, v19
  v_cvt_pk_bf16_f32 v24, v24, v25
  v_lshlrev_b32 v25, 16, v24
  v_and_b32 v24, 0xffff0000, v24
  v_add_f32 v70, v70, v25
  v_add_f32 v70, v70, v24
  v_lshlrev_b32 v24, 16, v58
  v_and_b32 v25, 0xffff0000, v58
  v_mul_f32 v24, v24, v20
  v_mul_f32 v25, v25, v21
  v_cvt_pk_bf16_f32 v24, v24, v25
  v_lshlrev_b32 v25, 16, v24
  v_and_b32 v24, 0xffff0000, v24
  v_add_f32 v70, v70, v25
  v_add_f32 v70, v70, v24
  v_lshlrev_b32 v24, 16, v59
  v_and_b32 v25, 0xffff0000, v59
  v_mul_f32 v24, v24, v22
  v_mul_f32 v25, v25, v23
  v_cvt_pk_bf16_f32 v24, v24, v25
  v_lshlrev_b32 v25, 16, v24
  v_and_b32 v24, 0xffff0000, v24
  v_add_f32 v70, v70, v25
  v_add_f32 v70, v70, v24
  v_lshlrev_b32 v24, 16, v60
  v_and_b32 v25, 0xffff0000, v60
  v_mul_f32 v24, v24, v16
  v_mul_f32 v25, v25, v17
  v_cvt_pk_bf16_f32 v24, v24, v25
  v_lshlrev_b32 v25, 16, v24
  v_and_b32 v24, 0xffff0000, v24
  v_add_f32 v71, v24, v25
  v_lshlrev_b32 v24, 16, v61
  v_and_b32 v25, 0xffff0000, v61
  v_mul_f32 v24, v24, v18
  v_mul_f32 v25, v25, v19
  v_cvt_pk_bf16_f32 v24, v24, v25
  v_lshlrev_b32 v25, 16, v24
  v_and_b32 v24, 0xffff0000, v24
  v_add_f32 v71, v71, v25
  v_add_f32 v71, v71, v24
  v_lshlrev_b32 v24, 16, v62
  v_and_b32 v25, 0xffff0000, v62
  v_mul_f32 v24, v24, v20
  v_mul_f32 v25, v25, v21
  v_cvt_pk_bf16_f32 v24, v24, v25
  v_lshlrev_b32 v25, 16, v24
  v_and_b32 v24, 0xffff0000, v24
  v_add_f32 v71, v71, v25
  v_add_f32 v71, v71, v24
  v_lshlrev_b32 v24, 16, v63
  v_and_b32 v25, 0xffff0000, v63
  v_mul_f32 v24, v24, v22
  v_mul_f32 v25, v25, v23
  v_cvt_pk_bf16_f32 v24, v24, v25
  v_lshlrev_b32 v25, 16, v24
  v_and_b32 v24, 0xffff0000, v24
  v_add_f32 v71, v71, v25
  v_add_f32 v71, v71, v24
  v_add_f32_dpp v64, v64, v64 row_shr:1
  v_add_f32_dpp v65, v65, v65 row_shr:1
  v_add_f32_dpp v66, v66, v66 row_shr:1
  v_add_f32_dpp v67, v67, v67 row_shr:1
  v_add_f32_dpp v68, v68, v68 row_shr:1
  v_add_f32_dpp v69, v69, v69 row_shr:1
  v_add_f32_dpp v70, v70, v70 row_shr:1
  v_add_f32_dpp v71, v71, v71 row_shr:1
  v_add_f32_dpp v64, v64, v64 row_shr:2
  v_add_f32_dpp v65, v65, v65 row_shr:2
  v_add_f32_dpp v66, v66, v66 row_shr:2
  v_add_f32_dpp v67, v67, v67 row_shr:2
  v_add_f32_dpp v68, v68, v68 row_shr:2
  v_add_f32_dpp v69, v69, v69 row_shr:2
  v_add_f32_dpp v70, v70, v70 row_shr:2
  v_add_f32_dpp v71, v71, v71 row_shr:2
  v_add_f32_dpp v64, v64, v64 row_shr:4
  v_add_f32_dpp v65, v65, v65 row_shr:4
  v_add_f32_dpp v66, v66, v66 row_shr:4
  v_add_f32_dpp v67, v67, v67 row_shr:4
  v_add_f32_dpp v68, v68, v68 row_shr:4
  v_add_f32_dpp v69, v69, v69 row_shr:4
  v_add_f32_dpp v70, v70, v70 row_shr:4
  v_add_f32_dpp v71, v71, v71 row_shr:4
  v_add_f32_dpp v64, v64, v64 row_shr:8
  v_add_f32_dpp v65, v65, v65 row_shr:8
  v_add_f32_dpp v66, v66, v66 row_shr:8
  v_add_f32_dpp v67, v67, v67 row_shr:8
  v_add_f32_dpp v68, v68, v68 row_shr:8
  v_add_f32_dpp v69, v69, v69 row_shr:8
  v_add_f32_dpp v70, v70, v70 row_shr:8
  v_add_f32_dpp v71, v71, v71 row_shr:8
  v_add_f32_dpp v64, v64, v64 row_bcast:15 row_mask:0xa
  v_add_f32_dpp v65, v65, v65 row_bcast:15 row_mask:0xa
  v_add_f32_dpp v66, v66, v66 row_bcast:15 row_mask:0xa
  v_add_f32_dpp v67, v67, v67 row_bcast:15 row_mask:0xa
  v_add_f32_dpp v68, v68, v68 row_bcast:15 row_mask:0xa
  v_add_f32_dpp v69, v69, v69 row_bcast:15 row_mask:0xa
  v_add_f32_dpp v70, v70, v70 row_bcast:15 row_mask:0xa
  v_add_f32_dpp v71, v71, v71 row_bcast:15 row_mask:0xa
  v_add_f32_dpp v64, v64, v64 row_bcast:31 row_mask:0xc
  v_add_f32_dpp v65, v65, v65 row_bcast:31 row_mask:0xc
  v_add_f32_dpp v66, v66, v66 row_bcast:31 row_mask:0xc
  v_add_f32_dpp v67, v67, v67 row_bcast:31 row_mask:0xc
  v_add_f32_dpp v68, v68, v68 row_bcast:31 row_mask:0xc
  v_add_f32_dpp v69, v69, v69 row_bcast:31 row_mask:0xc
  v_add_f32_dpp v70, v70, v70 row_bcast:31 row_mask:0xc
  v_add_f32_dpp v71, v71, v71 row_bcast:31 row_mask:0xc
  v_mov_b32 v24, 0
  v_readlane_b32 s66, v64, 63
  v_readlane_b32 s67, v65, 63
  v_readlane_b32 s68, v66, 63
  v_readlane_b32 s69, v67, 63
  v_readlane_b32 s70, v68, 63
  v_readlane_b32 s71, v69, 63
  v_readlane_b32 s72, v70, 63
  v_readlane_b32 s73, v71, 63
  v_writelane_b32 v24, s66, 0
  v_writelane_b32 v24, s67, 1
  v_writelane_b32 v24, s68, 2
  v_writelane_b32 v24, s69, 3
  v_writelane_b32 v24, s70, 4
  v_writelane_b32 v24, s71, 5
  v_writelane_b32 v24, s72, 6
  v_writelane_b32 v24, s73, 7
  v_cvt_pk_bf16_f32 v24, v24, v24
  v_and_b32 v24, 0xffff0000, v24
  v_mul_f32 v24, 3216550459, v24
  v_exp_f32 v24, v24
  s_nop 0
  v_add_f32 v24, 1.0, v24
  v_rcp_f32 v24, v24
  s_nop 0
  v_cvt_pk_bf16_f32 v24, v24, v24
  v_and_b32 v25, 0xffff0000, v24
  v_sub_f32 v25, 1.0, v25
  v_cvt_pk_bf16_f32 v25, v25, v25
  v_and_b32 v24, 0xffff, v24
  v_and_b32 v25, 0xffff0000, v25
  v_or_b32 v24, v24, v25
  v_mov_b32 v25, s8
  s_lshl_b32 s12, s64, 3
  s_add_u32 s12, s12, 393216
  v_lshl_add_u32 v26, v1, 3, s12
  s_mov_b64 exec, 0xff
  buffer_store_dwordx2 v[24:25], v26, s[44:47], 0 offen sc1
  s_mov_b64 exec, -1
  s_cmp_lt_u32 s3, 4
  s_cbranch_scc1 L_attn
  s_cmp_lg_u32 s3, 7
  s_cbranch_scc1 L_end
  v_mov_b32 v8, 0
  v_mov_b32 v9, 1
  s_mov_b64 exec, 1
  buffer_atomic_add v9, v8, s[48:51], 0 offen sc0
  s_waitcnt vmcnt(0)
  s_mov_b64 exec, -1
  v_readfirstlane_b32 s12, v9
  s_nop 0
  s_cmp_lg_u32 s12, 255
  s_cbranch_scc1 L_ep_36
  s_add_u32 s12, s9, 1
  v_mov_b32 v9, s12
  s_mov_b64 exec, 1
  buffer_store_dword v9, v8, s[44:47], 0 offen sc1
  s_mov_b64 exec, -1
L_ep_36:
  s_branch L_end
L_end:
  s_endpgm

.section .rodata,"a"
.p2align 6
.amdhsa_kernel gated_mix__softmax_full_mha__dense_activation_silu__prompt_kernel
  .amdhsa_next_free_vgpr 256
  .amdhsa_next_free_sgpr 102
  .amdhsa_accum_offset 256
  .amdhsa_group_segment_fixed_size 0
  .amdhsa_kernarg_size 80
  .amdhsa_user_sgpr_count 2
  .amdhsa_user_sgpr_kernarg_segment_ptr 1
  .amdhsa_system_sgpr_workgroup_id_x 1
.end_amdhsa_kernel
```
